```python
import torch

def _softmax(x, axis=-1):
    return torch.softmax(x, dim=axis)
def _gelu(x):
    return torch.nn.functional.gelu(x, approximate="tanh")
def _silu(x):
    return torch.nn.functional.silu(x)
def _sigmoid(x):
    return torch.sigmoid(x)
def _layernorm(x, axis=-1, eps=1e-5):
    m = x.mean(dim=axis, keepdim=True)
    v = x.var(dim=axis, keepdim=True, unbiased=False)
    return (x - m) / torch.sqrt(v + eps)
def _scatter_add(tgt, idx, src, axis=0):
    return tgt.clone().index_add_(axis, idx, src)
def _segment_sum(src, seg, n):
    out = torch.zeros((n,) + src.shape[1:], dtype=src.dtype)
    return out.index_add_(0, seg, src)
def _pad(x, pw):
    flat = tuple(v for pair in reversed(pw) for v in pair)
    return torch.nn.functional.pad(x, flat)

kernel_name = 'standalone__normalfloat_lut_codebook_lookup__prompt'

def setup_inputs():

    _w = (lambda a: (lambda t: t.to(torch.bfloat16) if t.is_floating_point() else t)(torch.as_tensor(a)))
    B, S, D, F = 1, 2048, 1024, 3584
    G = 128 if 128 > 0 else D
    D = (D // G) * G
    ng = D // G
    nf4 = torch.tensor([
        -1.0, -0.6961928009986877, -0.5250730514526367, -0.39491748809814453,
        -0.28444138169288635, -0.18477343022823334, -0.09105003625154495, 0.0,
        0.07958029955625534, 0.16093020141124725, 0.24611230194568634, 0.33791524171829224,
        0.44070982933044434, 0.5626170039176941, 0.7229568362236023, 1.0
    ], dtype=float)
    qw = torch.randint(0, 16, (D, F)).to(torch.int64)
    absmax = (torch.abs((lambda *s: torch.randn(*s, dtype=torch.bfloat16) * 0.05)(ng, F)) + 0.01).to(float)
    return {
        "x": _w((lambda *s: torch.randn(*s, dtype=torch.bfloat16) * 0.05)(B, S, D)),
        "qw": _w(qw),
        "codebook": _w(nf4),
        "absmax": _w(absmax),
    }

def reference(x, qw, codebook, absmax):
    B, S, D = x.shape
    ng, F = absmax.shape
    G = D // ng
    w_nf = codebook[qw]
    s = (lambda x, n, axis: torch.repeat_interleave(x, n, dim=axis))(absmax, G, axis=0)
    w = (lambda x, dt: x.to(dt))(w_nf * s, x.dtype)
    return torch.einsum("bsd,df->bsf", x, w)
```

```asm
; @launch grid=(256,1,1) block=(512,1,1) lds=162816
.amdgcn_target "amdgcn-amd-amdhsa--gfx950"
.text
.globl standalone__normalfloat_lut_codebook_lookup__prompt_kernel
.p2align 8
.type standalone__normalfloat_lut_codebook_lookup__prompt_kernel,@function
standalone__normalfloat_lut_codebook_lookup__prompt_kernel:
  s_cmp_ge_u32 s2, 256
  s_cbranch_scc1 L_done
  v_lshrrev_b32 v1, 6, v0
  v_and_b32 v2, 63, v0
  v_readfirstlane_b32 s20, v1
  s_getpc_b64 s[60:61]
L_pc:
  s_sub_u32 s60, s60, L_pc - standalone__normalfloat_lut_codebook_lookup__prompt_kernel
  s_subb_u32 s61, s61, 0
  s_and_b32 s62, s2, -8
  s_add_u32 s62, s62, s20
  s_lshl_b32 s62, s62, 6
  s_cmp_lt_u32 s62, L_end - standalone__normalfloat_lut_codebook_lookup__prompt_kernel
  s_cbranch_scc0 L_nocw
  s_load_dword s3, s[60:61], s62
L_nocw:
  s_load_dwordx2 s[28:29], s[0:1], 8
  s_load_dwordx2 s[36:37], s[0:1], 24
  s_load_dwordx2 s[40:41], s[0:1], 48
  s_load_dwordx2 s[32:33], s[0:1], 16
  s_load_dwordx2 s[24:25], s[0:1], 0
  s_load_dwordx2 s[44:45], s[0:1], 32
  s_memrealtime s[34:35]
  s_bfe_u32 s18, s2, 0x20003
  s_and_b32 s12, s2, 1
  s_lshl2_add_u32 s18, s12, s18
  s_bfe_u32 s19, s2, 0x20001
  s_lshr_b32 s14, s2, 5
  s_lshl3_add_u32 s19, s19, s14
  v_and_b32 v3, 15, v2
  v_lshrrev_b32 v4, 4, v2
  s_and_b32 s12, s20, 1
  s_lshr_b32 s14, s20, 2
  s_lshl1_add_u32 s15, s18, s14
  s_lshl1_add_u32 s17, s15, s12
  s_mul_i32 s4, s17, 458752
  s_mul_i32 s6, s19, 224
  s_lshl1_add_u32 s4, s6, s4
  s_mul_i32 s8, s18, 7168
  s_add_u32 s6, s6, s8
  s_and_b32 s5, s19, 3
  s_lshl_b32 s99, s5, 4
  s_and_b32 s100, s99, 16
  s_cselect_b32 s101, 0, 96
  s_bitcmp0_b32 s5, 1
  s_cselect_b32 s5, 64, 0
  s_add_u32 s100, s100, s5
  s_bitcmp0_b32 s20, 1
  s_cselect_b32 s5, 2, 1
  s_cselect_b32 s8, s99, s100
  v_lshlrev_b32 v8, s5, v3
  v_add_u32 v8, s8, v8
  v_mul_u32_u24 v7, 114688, v4
  v_lshl_add_u32 v9, v8, 2, v7
  v_lshlrev_b32 v8, 1, v8
  v_add_u32 v10, s101, v3
  v_lshl_add_u32 v11, v10, 2, v7
  v_lshlrev_b32 v10, 1, v10
  s_mov_b32 s30, 14680064
  s_mov_b32 s31, 0x20000
  s_mov_b32 s38, 57344
  s_mov_b32 s39, 0x20000
  s_mov_b32 s42, 7356416
  s_mov_b32 s43, 0x20000
  s_lshl_b32 s63, s19, 9
  s_add_u32 s63, s63, 7340032
  v_lshlrev_b32 v13, 3, v2
  s_cmp_lg_u32 s20, 7
  s_waitcnt lgkmcnt(0)
  s_cbranch_scc1 L_nosnap
  buffer_load_dwordx2 v[14:15], v13, s[40:43], s63 offen sc1
L_nosnap:
  s_load_dwordx8 s[52:59], s[32:33], 0
  s_cmp_ge_u32 s20, 4
  s_cbranch_scc0 L_qloads
  s_barrier
L_qloads:
  s_bitcmp1_b32 s20, 1
  s_cbranch_scc1 L_q3
  buffer_load_dwordx2 v[164:165], v8, s[36:39], s6 offen
  buffer_load_dwordx4 v[128:131], v9, s[28:31], s4 offen nt
  s_add_u32 s4, s4, 14336
  buffer_load_dwordx4 v[132:135], v9, s[28:31], s4 offen nt
  s_add_u32 s4, s4, 14336
  buffer_load_dwordx4 v[136:139], v9, s[28:31], s4 offen nt
  s_add_u32 s4, s4, 14336
  buffer_load_dwordx4 v[140:143], v9, s[28:31], s4 offen nt
  s_add_u32 s4, s4, 14336
  buffer_load_dwordx4 v[144:147], v9, s[28:31], s4 offen nt
  s_add_u32 s4, s4, 14336
  buffer_load_dwordx4 v[148:151], v9, s[28:31], s4 offen nt
  s_add_u32 s4, s4, 14336
  buffer_load_dwordx4 v[152:155], v9, s[28:31], s4 offen nt
  s_add_u32 s4, s4, 14336
  buffer_load_dwordx4 v[156:159], v9, s[28:31], s4 offen nt
  s_branch L_qd
L_q3:
  buffer_load_dword v164, v8, s[36:39], s6 offen
  buffer_load_ushort v165, v10, s[36:39], s6 offen
  buffer_load_dwordx2 v[128:129], v9, s[28:31], s4 offen nt
  buffer_load_dword v130, v11, s[28:31], s4 offen nt
  s_add_u32 s4, s4, 14336
  buffer_load_dwordx2 v[132:133], v9, s[28:31], s4 offen nt
  buffer_load_dword v134, v11, s[28:31], s4 offen nt
  s_add_u32 s4, s4, 14336
  buffer_load_dwordx2 v[136:137], v9, s[28:31], s4 offen nt
  buffer_load_dword v138, v11, s[28:31], s4 offen nt
  s_add_u32 s4, s4, 14336
  buffer_load_dwordx2 v[140:141], v9, s[28:31], s4 offen nt
  buffer_load_dword v142, v11, s[28:31], s4 offen nt
  s_add_u32 s4, s4, 14336
  buffer_load_dwordx2 v[144:145], v9, s[28:31], s4 offen nt
  buffer_load_dword v146, v11, s[28:31], s4 offen nt
  s_add_u32 s4, s4, 14336
  buffer_load_dwordx2 v[148:149], v9, s[28:31], s4 offen nt
  buffer_load_dword v150, v11, s[28:31], s4 offen nt
  s_add_u32 s4, s4, 14336
  buffer_load_dwordx2 v[152:153], v9, s[28:31], s4 offen nt
  buffer_load_dword v154, v11, s[28:31], s4 offen nt
  s_add_u32 s4, s4, 14336
  buffer_load_dwordx2 v[156:157], v9, s[28:31], s4 offen nt
  buffer_load_dword v158, v11, s[28:31], s4 offen nt
L_qd:
  s_cmp_ge_u32 s20, 4
  s_cbranch_scc1 L_rest
  s_barrier
L_rest:
  s_mov_b32 s26, 4194304
  s_mov_b32 s27, 0x20000
  s_mov_b32 s46, 14680064
  s_mov_b32 s47, 0x20000
  v_lshlrev_b32 v5, 4, v2
  s_xor_b32 s35, s35, 0x5bd1e995
  s_xor_b32 s11, s34, s35
  v_mov_b32 v184, s34
  v_mov_b32 v185, s11
  s_sub_u32 s11, s34, 500
  s_mov_b32 s9, s35
  s_and_b32 s21, s20, 3
  s_lshl_b32 s16, s18, 1
  s_lshl_b32 s7, s19, 5
  s_add_u32 s7, s7, s17
  s_mul_i32 s7, s7, 7168
  s_and_b32 s5, s20, 2
  s_lshl_b32 s5, s5, 11
  s_add_u32 s7, s7, s5
  s_mul_i32 s8, s14, 47104
  s_add_u32 s8, s8, s5
  s_mul_i32 s5, s12, 7168
  s_add_u32 s8, s8, s5
  s_add_u32 s8, s8, 32768
  v_add_u32 v6, s8, v5
  s_lshl_b32 s10, s15, 5
  s_lshl3_add_u32 s10, s21, s10
  s_add_u32 s10, s10, s63
  s_cmp_ge_u32 s20, 4
  s_cbranch_scc1 L_helper
  s_branch L_mfma
L_produce:
  s_waitcnt lgkmcnt(0)
  s_lshl_b32 s3, s52, 16
  v_writelane_b32 v12, s3, 0
  v_writelane_b32 v12, s3, 48
  s_and_b32 s3, s52, 0xffff0000
  v_writelane_b32 v12, s3, 1
  v_writelane_b32 v12, s3, 49
  s_lshl_b32 s3, s53, 16
  v_writelane_b32 v12, s3, 2
  v_writelane_b32 v12, s3, 50
  s_and_b32 s3, s53, 0xffff0000
  v_writelane_b32 v12, s3, 3
  v_writelane_b32 v12, s3, 51
  s_lshl_b32 s3, s54, 16
  v_writelane_b32 v12, s3, 4
  v_writelane_b32 v12, s3, 52
  s_and_b32 s3, s54, 0xffff0000
  v_writelane_b32 v12, s3, 5
  v_writelane_b32 v12, s3, 53
  s_lshl_b32 s3, s55, 16
  v_writelane_b32 v12, s3, 6
  v_writelane_b32 v12, s3, 54
  s_and_b32 s3, s55, 0xffff0000
  v_writelane_b32 v12, s3, 7
  v_writelane_b32 v12, s3, 55
  s_lshl_b32 s3, s56, 16
  v_writelane_b32 v12, s3, 8
  v_writelane_b32 v12, s3, 56
  s_and_b32 s3, s56, 0xffff0000
  v_writelane_b32 v12, s3, 9
  v_writelane_b32 v12, s3, 57
  s_lshl_b32 s3, s57, 16
  v_writelane_b32 v12, s3, 10
  v_writelane_b32 v12, s3, 58
  s_and_b32 s3, s57, 0xffff0000
  v_writelane_b32 v12, s3, 11
  v_writelane_b32 v12, s3, 59
  s_lshl_b32 s3, s58, 16
  v_writelane_b32 v12, s3, 12
  v_writelane_b32 v12, s3, 60
  s_and_b32 s3, s58, 0xffff0000
  v_writelane_b32 v12, s3, 13
  v_writelane_b32 v12, s3, 61
  s_lshl_b32 s3, s59, 16
  v_writelane_b32 v12, s3, 14
  v_writelane_b32 v12, s3, 62
  s_and_b32 s3, s59, 0xffff0000
  v_writelane_b32 v12, s3, 15
  v_writelane_b32 v12, s3, 63
  v_mov_b32 v186, s10
  s_bitcmp1_b32 s20, 1
  s_cbranch_scc1 L_p3
  s_waitcnt vmcnt(8)
  v_lshlrev_b32 v160, 16, v164
  v_and_b32 v161, 0xffff0000, v164
  v_lshlrev_b32 v162, 16, v165
  v_and_b32 v163, 0xffff0000, v165
  s_waitcnt vmcnt(7)
  v_lshlrev_b32 v128, 2, v128
  v_lshlrev_b32 v129, 2, v129
  v_lshlrev_b32 v130, 2, v130
  v_lshlrev_b32 v131, 2, v131
  ds_bpermute_b32 v128, v128, v12
  ds_bpermute_b32 v129, v129, v12
  ds_bpermute_b32 v130, v130, v12
  ds_bpermute_b32 v131, v131, v12
  s_waitcnt vmcnt(6)
  v_lshlrev_b32 v132, 2, v132
  v_lshlrev_b32 v133, 2, v133
  v_lshlrev_b32 v134, 2, v134
  v_lshlrev_b32 v135, 2, v135
  ds_bpermute_b32 v132, v132, v12
  ds_bpermute_b32 v133, v133, v12
  ds_bpermute_b32 v134, v134, v12
  ds_bpermute_b32 v135, v135, v12
  s_waitcnt lgkmcnt(4)
  v_mul_f32 v128, v128, v160
  v_mul_f32 v129, v129, v161
  v_mul_f32 v130, v130, v162
  v_mul_f32 v131, v131, v163
  s_waitcnt vmcnt(5)
  v_lshlrev_b32 v136, 2, v136
  v_lshlrev_b32 v137, 2, v137
  v_lshlrev_b32 v138, 2, v138
  v_lshlrev_b32 v139, 2, v139
  ds_bpermute_b32 v136, v136, v12
  ds_bpermute_b32 v137, v137, v12
  ds_bpermute_b32 v138, v138, v12
  ds_bpermute_b32 v139, v139, v12
  s_waitcnt lgkmcnt(4)
  v_mul_f32 v132, v132, v160
  v_mul_f32 v133, v133, v161
  v_mul_f32 v134, v134, v162
  v_mul_f32 v135, v135, v163
  v_cvt_pk_bf16_f32 v168, v128, v132
  v_cvt_pk_bf16_f32 v172, v129, v133
  v_cvt_pk_bf16_f32 v176, v130, v134
  v_cvt_pk_bf16_f32 v180, v131, v135
  s_waitcnt vmcnt(4)
  v_lshlrev_b32 v140, 2, v140
  v_lshlrev_b32 v141, 2, v141
  v_lshlrev_b32 v142, 2, v142
  v_lshlrev_b32 v143, 2, v143
  ds_bpermute_b32 v140, v140, v12
  ds_bpermute_b32 v141, v141, v12
  ds_bpermute_b32 v142, v142, v12
  ds_bpermute_b32 v143, v143, v12
  s_waitcnt lgkmcnt(4)
  v_mul_f32 v136, v136, v160
  v_mul_f32 v137, v137, v161
  v_mul_f32 v138, v138, v162
  v_mul_f32 v139, v139, v163
  s_waitcnt vmcnt(3)
  v_lshlrev_b32 v144, 2, v144
  v_lshlrev_b32 v145, 2, v145
  v_lshlrev_b32 v146, 2, v146
  v_lshlrev_b32 v147, 2, v147
  ds_bpermute_b32 v144, v144, v12
  ds_bpermute_b32 v145, v145, v12
  ds_bpermute_b32 v146, v146, v12
  ds_bpermute_b32 v147, v147, v12
  s_waitcnt lgkmcnt(4)
  v_mul_f32 v140, v140, v160
  v_mul_f32 v141, v141, v161
  v_mul_f32 v142, v142, v162
  v_mul_f32 v143, v143, v163
  v_cvt_pk_bf16_f32 v169, v136, v140
  v_cvt_pk_bf16_f32 v173, v137, v141
  v_cvt_pk_bf16_f32 v177, v138, v142
  v_cvt_pk_bf16_f32 v181, v139, v143
  s_waitcnt vmcnt(2)
  v_lshlrev_b32 v148, 2, v148
  v_lshlrev_b32 v149, 2, v149
  v_lshlrev_b32 v150, 2, v150
  v_lshlrev_b32 v151, 2, v151
  ds_bpermute_b32 v148, v148, v12
  ds_bpermute_b32 v149, v149, v12
  ds_bpermute_b32 v150, v150, v12
  ds_bpermute_b32 v151, v151, v12
  s_waitcnt lgkmcnt(4)
  v_mul_f32 v144, v144, v160
  v_mul_f32 v145, v145, v161
  v_mul_f32 v146, v146, v162
  v_mul_f32 v147, v147, v163
  s_waitcnt vmcnt(1)
  v_lshlrev_b32 v152, 2, v152
  v_lshlrev_b32 v153, 2, v153
  v_lshlrev_b32 v154, 2, v154
  v_lshlrev_b32 v155, 2, v155
  ds_bpermute_b32 v152, v152, v12
  ds_bpermute_b32 v153, v153, v12
  ds_bpermute_b32 v154, v154, v12
  ds_bpermute_b32 v155, v155, v12
  s_waitcnt lgkmcnt(4)
  v_mul_f32 v148, v148, v160
  v_mul_f32 v149, v149, v161
  v_mul_f32 v150, v150, v162
  v_mul_f32 v151, v151, v163
  v_cvt_pk_bf16_f32 v170, v144, v148
  v_cvt_pk_bf16_f32 v174, v145, v149
  v_cvt_pk_bf16_f32 v178, v146, v150
  v_cvt_pk_bf16_f32 v182, v147, v151
  s_waitcnt vmcnt(0)
  v_lshlrev_b32 v156, 2, v156
  v_lshlrev_b32 v157, 2, v157
  v_lshlrev_b32 v158, 2, v158
  v_lshlrev_b32 v159, 2, v159
  ds_bpermute_b32 v156, v156, v12
  ds_bpermute_b32 v157, v157, v12
  ds_bpermute_b32 v158, v158, v12
  ds_bpermute_b32 v159, v159, v12
  s_waitcnt lgkmcnt(4)
  v_mul_f32 v152, v152, v160
  v_mul_f32 v153, v153, v161
  v_mul_f32 v154, v154, v162
  v_mul_f32 v155, v155, v163
  s_waitcnt lgkmcnt(0)
  v_mul_f32 v156, v156, v160
  v_mul_f32 v157, v157, v161
  v_mul_f32 v158, v158, v162
  v_mul_f32 v159, v159, v163
  s_cmp_ge_u32 s20, 4
  v_cvt_pk_bf16_f32 v171, v152, v156
  v_cvt_pk_bf16_f32 v175, v153, v157
  v_cvt_pk_bf16_f32 v179, v154, v158
  v_cvt_pk_bf16_f32 v183, v155, v159
  s_cbranch_scc1 L_nost4
  buffer_store_dwordx4 v[168:171], v5, s[40:43], s7 offen offset:0 sc1
  buffer_store_dwordx4 v[172:175], v5, s[40:43], s7 offen offset:1024 sc1
  buffer_store_dwordx4 v[176:179], v5, s[40:43], s7 offen offset:2048 sc1
  buffer_store_dwordx4 v[180:183], v5, s[40:43], s7 offen offset:3072 sc1
L_nost4:
  ds_write_b128 v6, v[168:171] offset:0
  ds_write_b128 v6, v[172:175] offset:1024
  ds_write_b128 v6, v[176:179] offset:2048
  ds_write_b128 v6, v[180:183] offset:3072
  s_setpc_b64 s[60:61]
L_p3:
  s_waitcnt vmcnt(16)
  v_lshlrev_b32 v160, 16, v164
  v_and_b32 v161, 0xffff0000, v164
  v_lshlrev_b32 v162, 16, v165
  s_waitcnt vmcnt(14)
  v_lshlrev_b32 v128, 2, v128
  v_lshlrev_b32 v129, 2, v129
  v_lshlrev_b32 v130, 2, v130
  ds_bpermute_b32 v128, v128, v12
  ds_bpermute_b32 v129, v129, v12
  ds_bpermute_b32 v130, v130, v12
  s_waitcnt vmcnt(12)
  v_lshlrev_b32 v132, 2, v132
  v_lshlrev_b32 v133, 2, v133
  v_lshlrev_b32 v134, 2, v134
  ds_bpermute_b32 v132, v132, v12
  ds_bpermute_b32 v133, v133, v12
  ds_bpermute_b32 v134, v134, v12
  s_waitcnt lgkmcnt(3)
  v_mul_f32 v128, v128, v160
  v_mul_f32 v129, v129, v161
  v_mul_f32 v130, v130, v162
  s_waitcnt vmcnt(10)
  v_lshlrev_b32 v136, 2, v136
  v_lshlrev_b32 v137, 2, v137
  v_lshlrev_b32 v138, 2, v138
  ds_bpermute_b32 v136, v136, v12
  ds_bpermute_b32 v137, v137, v12
  ds_bpermute_b32 v138, v138, v12
  s_waitcnt lgkmcnt(3)
  v_mul_f32 v132, v132, v160
  v_mul_f32 v133, v133, v161
  v_mul_f32 v134, v134, v162
  v_cvt_pk_bf16_f32 v168, v128, v132
  v_cvt_pk_bf16_f32 v172, v129, v133
  v_cvt_pk_bf16_f32 v176, v130, v134
  s_waitcnt vmcnt(8)
  v_lshlrev_b32 v140, 2, v140
  v_lshlrev_b32 v141, 2, v141
  v_lshlrev_b32 v142, 2, v142
  ds_bpermute_b32 v140, v140, v12
  ds_bpermute_b32 v141, v141, v12
  ds_bpermute_b32 v142, v142, v12
  s_waitcnt lgkmcnt(3)
  v_mul_f32 v136, v136, v160
  v_mul_f32 v137, v137, v161
  v_mul_f32 v138, v138, v162
  s_waitcnt vmcnt(6)
  v_lshlrev_b32 v144, 2, v144
  v_lshlrev_b32 v145, 2, v145
  v_lshlrev_b32 v146, 2, v146
  ds_bpermute_b32 v144, v144, v12
  ds_bpermute_b32 v145, v145, v12
  ds_bpermute_b32 v146, v146, v12
  s_waitcnt lgkmcnt(3)
  v_mul_f32 v140, v140, v160
  v_mul_f32 v141, v141, v161
  v_mul_f32 v142, v142, v162
  v_cvt_pk_bf16_f32 v169, v136, v140
  v_cvt_pk_bf16_f32 v173, v137, v141
  v_cvt_pk_bf16_f32 v177, v138, v142
  s_waitcnt vmcnt(4)
  v_lshlrev_b32 v148, 2, v148
  v_lshlrev_b32 v149, 2, v149
  v_lshlrev_b32 v150, 2, v150
  ds_bpermute_b32 v148, v148, v12
  ds_bpermute_b32 v149, v149, v12
  ds_bpermute_b32 v150, v150, v12
  s_waitcnt lgkmcnt(3)
  v_mul_f32 v144, v144, v160
  v_mul_f32 v145, v145, v161
  v_mul_f32 v146, v146, v162
  s_waitcnt vmcnt(2)
  v_lshlrev_b32 v152, 2, v152
  v_lshlrev_b32 v153, 2, v153
  v_lshlrev_b32 v154, 2, v154
  ds_bpermute_b32 v152, v152, v12
  ds_bpermute_b32 v153, v153, v12
  ds_bpermute_b32 v154, v154, v12
  s_waitcnt lgkmcnt(3)
  v_mul_f32 v148, v148, v160
  v_mul_f32 v149, v149, v161
  v_mul_f32 v150, v150, v162
  v_cvt_pk_bf16_f32 v170, v144, v148
  v_cvt_pk_bf16_f32 v174, v145, v149
  v_cvt_pk_bf16_f32 v178, v146, v150
  s_waitcnt vmcnt(0)
  v_lshlrev_b32 v156, 2, v156
  v_lshlrev_b32 v157, 2, v157
  v_lshlrev_b32 v158, 2, v158
  ds_bpermute_b32 v156, v156, v12
  ds_bpermute_b32 v157, v157, v12
  ds_bpermute_b32 v158, v158, v12
  s_waitcnt lgkmcnt(3)
  v_mul_f32 v152, v152, v160
  v_mul_f32 v153, v153, v161
  v_mul_f32 v154, v154, v162
  s_waitcnt lgkmcnt(0)
  v_mul_f32 v156, v156, v160
  v_mul_f32 v157, v157, v161
  v_mul_f32 v158, v158, v162
  s_cmp_ge_u32 s20, 4
  v_cvt_pk_bf16_f32 v171, v152, v156
  v_cvt_pk_bf16_f32 v175, v153, v157
  v_cvt_pk_bf16_f32 v179, v154, v158
  s_cbranch_scc1 L_nost3
  buffer_store_dwordx4 v[168:171], v5, s[40:43], s7 offen offset:0 sc1
  buffer_store_dwordx4 v[172:175], v5, s[40:43], s7 offen offset:1024 sc1
  buffer_store_dwordx4 v[176:179], v5, s[40:43], s7 offen offset:2048 sc1
L_nost3:
  ds_write_b128 v6, v[168:171] offset:0
  ds_write_b128 v6, v[172:175] offset:1024
  ds_write_b128 v6, v[176:179] offset:2048
  s_setpc_b64 s[60:61]
L_mfma:
  v_lshrrev_b32 v1, 3, v2
  v_and_b32 v192, 7, v2
  v_xor_b32 v192, v192, v1
  v_lshlrev_b32 v192, 4, v192
  v_lshl_add_u32 v192, v1, 11, v192
  s_lshl_b32 s5, s18, 19
  s_lshl_b32 s8, s20, 17
  s_add_u32 s5, s5, s8
  v_add_u32 v192, s5, v192
  v_add_u32 v193, 15360, v192
  v_add_u32 v194, 30720, v192
  v_add_u32 v195, 46080, v192
  v_add_u32 v196, 65536, v192
  v_add_u32 v197, 80896, v192
  v_add_u32 v198, 96256, v192
  v_add_u32 v199, 111616, v192
  s_lshl_b32 s8, s20, 13
  s_lshl_b32 s17, s16, 7
  v_and_b32 v1, 7, v2
  v_xor_b32 v1, v1, v4
  v_lshlrev_b32 v9, 7, v3
  v_add_u32 v9, s8, v9
  v_lshl_add_u32 v8, v1, 4, v9
  v_xor_b32 v9, 64, v8
  v_add_u32 v10, 32768, v5
  v_mov_b32 v11, v8
  v_mov_b32 v14, v9
  v_mov_b32 v13, v10
  v_add_u32 v216, 94208, v8
  v_add_u32 v217, 94208, v9
  v_add_u32 v218, 94208, v10
  v_mul_u32_u24 v219, 112, v3
  v_lshl_add_u32 v219, v4, 4, v219
  s_lshr_b32 s5, s20, 1
  s_mul_i32 s5, s5, 47104
  s_and_b32 s6, s20, 1
  s_mul_i32 s6, s6, 7168
  s_add_u32 s5, s5, s6
  s_add_u32 s5, s5, 36864
  v_add_u32 v220, s5, v219
  s_mul_i32 s5, s20, 5376
  s_add_u32 s5, s5, 141312
  v_add_u32 v219, s5, v219
  v_lshlrev_b32 v1, 3, v4
  v_sub_u32 v224, v219, v1
  v_sub_u32 v225, v220, v1
  s_mul_i32 s5, s20, 9216
  s_add_u32 s5, s5, 47104
  v_mul_u32_u24 v221, 144, v3
  v_lshl_add_u32 v221, v4, 5, v221
  v_add_u32 v221, s5, v221
  v_lshrrev_b32 v1, 3, v2
  v_and_b32 v223, 7, v2
  v_lshlrev_b32 v223, 4, v223
  v_mul_u32_u24 v222, 144, v1
  v_add3_u32 v222, v222, v223, s5
  v_mul_u32_u24 v1, 7168, v1
  s_lshl_b32 s6, s99, 1
  v_add3_u32 v223, v223, v1, s6
  s_lshl_b32 s9, s18, 8
  s_lshl_b32 s6, s20, 6
  s_add_u32 s9, s9, s6
  s_mul_i32 s9, s9, 7168
  s_mul_i32 s6, s19, 224
  s_add_u32 s9, s9, s6
  s_add_u32 s9, s9, 229376
  s_mov_b32 s22, 0
  s_mov_b32 s23, 0
  v_mov_b32 v16, 0
  v_mov_b32 v17, 0
  v_mov_b32 v18, 0
  v_mov_b32 v19, 0
  v_mov_b32 v20, 0
  v_mov_b32 v21, 0
  v_mov_b32 v22, 0
  v_mov_b32 v23, 0
  v_mov_b32 v24, 0
  v_mov_b32 v25, 0
  v_mov_b32 v26, 0
  v_mov_b32 v27, 0
  v_mov_b32 v28, 0
  v_mov_b32 v29, 0
  v_mov_b32 v30, 0
  v_mov_b32 v31, 0
  v_mov_b32 v32, 0
  v_mov_b32 v33, 0
  v_mov_b32 v34, 0
  v_mov_b32 v35, 0
  v_mov_b32 v36, 0
  v_mov_b32 v37, 0
  v_mov_b32 v38, 0
  v_mov_b32 v39, 0
  v_mov_b32 v40, 0
  v_mov_b32 v41, 0
  v_mov_b32 v42, 0
  v_mov_b32 v43, 0
  v_mov_b32 v44, 0
  v_mov_b32 v45, 0
  v_mov_b32 v46, 0
  v_mov_b32 v47, 0
  v_mov_b32 v48, 0
  v_mov_b32 v49, 0
  v_mov_b32 v50, 0
  v_mov_b32 v51, 0
  v_mov_b32 v52, 0
  v_mov_b32 v53, 0
  v_mov_b32 v54, 0
  v_mov_b32 v55, 0
  v_mov_b32 v56, 0
  v_mov_b32 v57, 0
  v_mov_b32 v58, 0
  v_mov_b32 v59, 0
  v_mov_b32 v60, 0
  v_mov_b32 v61, 0
  v_mov_b32 v62, 0
  v_mov_b32 v63, 0
  v_mov_b32 v64, 0
  v_mov_b32 v65, 0
  v_mov_b32 v66, 0
  v_mov_b32 v67, 0
  v_mov_b32 v68, 0
  v_mov_b32 v69, 0
  v_mov_b32 v70, 0
  v_mov_b32 v71, 0
  v_mov_b32 v72, 0
  v_mov_b32 v73, 0
  v_mov_b32 v74, 0
  v_mov_b32 v75, 0
  v_mov_b32 v76, 0
  v_mov_b32 v77, 0
  v_mov_b32 v78, 0
  v_mov_b32 v79, 0
  v_mov_b32 v80, 0
  v_mov_b32 v81, 0
  v_mov_b32 v82, 0
  v_mov_b32 v83, 0
  v_mov_b32 v84, 0
  v_mov_b32 v85, 0
  v_mov_b32 v86, 0
  v_mov_b32 v87, 0
  v_mov_b32 v88, 0
  v_mov_b32 v89, 0
  v_mov_b32 v90, 0
  v_mov_b32 v91, 0
  v_mov_b32 v92, 0
  v_mov_b32 v93, 0
  v_mov_b32 v94, 0
  v_mov_b32 v95, 0
  v_mov_b32 v96, 0
  v_mov_b32 v97, 0
  v_mov_b32 v98, 0
  v_mov_b32 v99, 0
  v_mov_b32 v100, 0
  v_mov_b32 v101, 0
  v_mov_b32 v102, 0
  v_mov_b32 v103, 0
  v_mov_b32 v104, 0
  v_mov_b32 v105, 0
  v_mov_b32 v106, 0
  v_mov_b32 v107, 0
  v_mov_b32 v108, 0
  v_mov_b32 v109, 0
  v_mov_b32 v110, 0
  v_mov_b32 v111, 0
  v_mov_b32 v112, 0
  v_mov_b32 v113, 0
  v_mov_b32 v114, 0
  v_mov_b32 v115, 0
  v_mov_b32 v116, 0
  v_mov_b32 v117, 0
  v_mov_b32 v118, 0
  v_mov_b32 v119, 0
  v_mov_b32 v120, 0
  v_mov_b32 v121, 0
  v_mov_b32 v122, 0
  v_mov_b32 v123, 0
  v_mov_b32 v124, 0
  v_mov_b32 v125, 0
  v_mov_b32 v126, 0
  v_mov_b32 v127, 0
  s_call_b64 s[60:61], L_produce
  v_mov_b32 v12, v14
  s_waitcnt lgkmcnt(0)
  s_barrier
  s_add_u32 m0, s8, 0
  s_nop 0
  buffer_load_dwordx4 v192, s[24:27], s17 offen offset:0 lds
  buffer_load_dwordx4 v193, s[24:27], s17 offen offset:1024 lds
  buffer_load_dwordx4 v194, s[24:27], s17 offen offset:2048 lds
  buffer_load_dwordx4 v195, s[24:27], s17 offen offset:3072 lds
  s_add_u32 m0, m0, 4096
  s_nop 0
  buffer_load_dwordx4 v196, s[24:27], s17 offen offset:0 lds
  buffer_load_dwordx4 v197, s[24:27], s17 offen offset:1024 lds
  buffer_load_dwordx4 v198, s[24:27], s17 offen offset:2048 lds
  buffer_load_dwordx4 v199, s[24:27], s17 offen offset:3072 lds
  s_lshl2_add_u32 s5, s19, s20
  s_lshl_b32 s5, s5, 12
  s_lshl_b32 s6, s18, 19
  s_add_u32 s5, s5, s6
  s_add_u32 s6, s16, 2
  s_and_b32 s6, s6, 15
  s_lshl_b32 s6, s6, 7
  s_add_u32 s6, s6, s5
  s_buffer_load_dword s3, s[24:27], s6 offset:0
  s_buffer_load_dword s3, s[24:27], s6 offset:64
  s_buffer_load_dword s3, s[24:27], s6 offset:2048
  s_buffer_load_dword s3, s[24:27], s6 offset:2112
  s_add_u32 s6, s16, 4
  s_and_b32 s6, s6, 15
  s_lshl_b32 s6, s6, 7
  s_add_u32 s6, s6, s5
  s_buffer_load_dword s3, s[24:27], s6 offset:0
  s_buffer_load_dword s3, s[24:27], s6 offset:64
  s_buffer_load_dword s3, s[24:27], s6 offset:2048
  s_buffer_load_dword s3, s[24:27], s6 offset:2112
  s_add_u32 s6, s16, 6
  s_and_b32 s6, s6, 15
  s_lshl_b32 s6, s6, 7
  s_add_u32 s6, s6, s5
  s_buffer_load_dword s3, s[24:27], s6 offset:0
  s_buffer_load_dword s3, s[24:27], s6 offset:64
  s_buffer_load_dword s3, s[24:27], s6 offset:2048
  s_buffer_load_dword s3, s[24:27], s6 offset:2112
  s_waitcnt vmcnt(8)
  s_mov_b64 exec, 1
  buffer_store_dwordx2 v[184:185], v186, s[40:43], 0 offen sc1
  s_mov_b64 exec, -1
  s_add_u32 m0, s8, 47104
  s_add_u32 s17, s17, 128
  buffer_load_dwordx4 v192, s[24:27], s17 offen offset:0 lds
  buffer_load_dwordx4 v193, s[24:27], s17 offen offset:1024 lds
  buffer_load_dwordx4 v194, s[24:27], s17 offen offset:2048 lds
  buffer_load_dwordx4 v195, s[24:27], s17 offen offset:3072 lds
  s_add_u32 m0, m0, 4096
  s_nop 0
  buffer_load_dwordx4 v196, s[24:27], s17 offen offset:0 lds
  buffer_load_dwordx4 v197, s[24:27], s17 offen offset:1024 lds
  buffer_load_dwordx4 v198, s[24:27], s17 offen offset:2048 lds
  buffer_load_dwordx4 v199, s[24:27], s17 offen offset:3072 lds
  s_barrier
  s_waitcnt vmcnt(9)
  ds_read_b128 v[128:131], v11 offset:0
  ds_read_b128 v[132:135], v11 offset:2048
  ds_read_b128 v[136:139], v11 offset:4096
  ds_read_b128 v[140:143], v11 offset:6144
  ds_read_b128 v[144:147], v13 offset:0
  ds_read_b128 v[148:151], v13 offset:1024
  ds_read_b128 v[152:155], v13 offset:2048
  ds_read_b128 v[156:159], v13 offset:3072
  ds_read_b128 v[160:163], v13 offset:4096
  ds_read_b128 v[164:167], v13 offset:5120
  ds_read_b128 v[168:171], v13 offset:6144
.p2align 6
L_loop:
  s_waitcnt lgkmcnt(0)
  v_mfma_f32_16x16x32_bf16 v[16:19], v[144:147], v[128:131], v[16:19]
  ds_read_b128 v[172:175], v12 offset:0
  v_mfma_f32_16x16x32_bf16 v[44:47], v[144:147], v[132:135], v[44:47]
  v_mfma_f32_16x16x32_bf16 v[72:75], v[144:147], v[136:139], v[72:75]
  ds_read_b128 v[176:179], v12 offset:2048
  v_mfma_f32_16x16x32_bf16 v[100:103], v[144:147], v[140:143], v[100:103]
  v_mfma_f32_16x16x32_bf16 v[20:23], v[148:151], v[128:131], v[20:23]
  ds_read_b128 v[180:183], v12 offset:4096
  v_mfma_f32_16x16x32_bf16 v[48:51], v[148:151], v[132:135], v[48:51]
  v_mfma_f32_16x16x32_bf16 v[76:79], v[148:151], v[136:139], v[76:79]
  ds_read_b128 v[184:187], v12 offset:6144
  v_mfma_f32_16x16x32_bf16 v[104:107], v[148:151], v[140:143], v[104:107]
  v_mfma_f32_16x16x32_bf16 v[24:27], v[152:155], v[128:131], v[24:27]
  ds_read_b128 v[188:191], v13 offset:7168
  v_mfma_f32_16x16x32_bf16 v[52:55], v[152:155], v[132:135], v[52:55]
  v_mfma_f32_16x16x32_bf16 v[80:83], v[152:155], v[136:139], v[80:83]
  ds_read_b128 v[192:195], v13 offset:8192
  v_mfma_f32_16x16x32_bf16 v[108:111], v[152:155], v[140:143], v[108:111]
  v_mfma_f32_16x16x32_bf16 v[28:31], v[156:159], v[128:131], v[28:31]
  ds_read_b128 v[196:199], v13 offset:9216
  v_mfma_f32_16x16x32_bf16 v[56:59], v[156:159], v[132:135], v[56:59]
  v_mfma_f32_16x16x32_bf16 v[84:87], v[156:159], v[136:139], v[84:87]
  ds_read_b128 v[200:203], v13 offset:10240
  v_mfma_f32_16x16x32_bf16 v[112:115], v[156:159], v[140:143], v[112:115]
  v_mfma_f32_16x16x32_bf16 v[32:35], v[160:163], v[128:131], v[32:35]
  ds_read_b128 v[204:207], v13 offset:11264
  v_mfma_f32_16x16x32_bf16 v[60:63], v[160:163], v[132:135], v[60:63]
  v_mfma_f32_16x16x32_bf16 v[88:91], v[160:163], v[136:139], v[88:91]
  ds_read_b128 v[208:211], v13 offset:12288
  v_mfma_f32_16x16x32_bf16 v[116:119], v[160:163], v[140:143], v[116:119]
  v_mfma_f32_16x16x32_bf16 v[36:39], v[164:167], v[128:131], v[36:39]
  ds_read_b128 v[212:215], v13 offset:13312
  v_mfma_f32_16x16x32_bf16 v[64:67], v[164:167], v[132:135], v[64:67]
  v_mfma_f32_16x16x32_bf16 v[92:95], v[164:167], v[136:139], v[92:95]
  s_add_u32 s22, s22, 47104
  s_cmp_eq_u32 s22, 141312
  s_cselect_b32 s22, 0, s22
  v_mfma_f32_16x16x32_bf16 v[120:123], v[164:167], v[140:143], v[120:123]
  v_add_u32 v11, s22, v8
  v_mfma_f32_16x16x32_bf16 v[40:43], v[168:171], v[128:131], v[40:43]
  v_add_u32 v12, s22, v9
  v_mfma_f32_16x16x32_bf16 v[68:71], v[168:171], v[132:135], v[68:71]
  v_add_u32 v13, s22, v10
  v_mfma_f32_16x16x32_bf16 v[96:99], v[168:171], v[136:139], v[96:99]
  v_mfma_f32_16x16x32_bf16 v[124:127], v[168:171], v[140:143], v[124:127]
  s_waitcnt vmcnt(0) lgkmcnt(0)
  s_barrier
  v_mfma_f32_16x16x32_bf16 v[16:19], v[188:191], v[172:175], v[16:19]
  ds_read_b128 v[128:131], v11 offset:0
  v_mfma_f32_16x16x32_bf16 v[44:47], v[188:191], v[176:179], v[44:47]
  v_mfma_f32_16x16x32_bf16 v[72:75], v[188:191], v[180:183], v[72:75]
  ds_read_b128 v[132:135], v11 offset:2048
  v_mfma_f32_16x16x32_bf16 v[100:103], v[188:191], v[184:187], v[100:103]
  v_mfma_f32_16x16x32_bf16 v[20:23], v[192:195], v[172:175], v[20:23]
  ds_read_b128 v[136:139], v11 offset:4096
  v_mfma_f32_16x16x32_bf16 v[48:51], v[192:195], v[176:179], v[48:51]
  v_mfma_f32_16x16x32_bf16 v[76:79], v[192:195], v[180:183], v[76:79]
  ds_read_b128 v[140:143], v11 offset:6144
  v_mfma_f32_16x16x32_bf16 v[104:107], v[192:195], v[184:187], v[104:107]
  v_mfma_f32_16x16x32_bf16 v[24:27], v[196:199], v[172:175], v[24:27]
  ds_read_b128 v[144:147], v13 offset:0
  v_mfma_f32_16x16x32_bf16 v[52:55], v[196:199], v[176:179], v[52:55]
  v_mfma_f32_16x16x32_bf16 v[80:83], v[196:199], v[180:183], v[80:83]
  ds_read_b128 v[148:151], v13 offset:1024
  v_mfma_f32_16x16x32_bf16 v[108:111], v[196:199], v[184:187], v[108:111]
  v_mfma_f32_16x16x32_bf16 v[28:31], v[200:203], v[172:175], v[28:31]
  ds_read_b128 v[152:155], v13 offset:2048
  v_mfma_f32_16x16x32_bf16 v[56:59], v[200:203], v[176:179], v[56:59]
  v_mfma_f32_16x16x32_bf16 v[84:87], v[200:203], v[180:183], v[84:87]
  ds_read_b128 v[156:159], v13 offset:3072
  v_mfma_f32_16x16x32_bf16 v[112:115], v[200:203], v[184:187], v[112:115]
  v_mfma_f32_16x16x32_bf16 v[32:35], v[204:207], v[172:175], v[32:35]
  ds_read_b128 v[160:163], v13 offset:4096
  v_mfma_f32_16x16x32_bf16 v[60:63], v[204:207], v[176:179], v[60:63]
  v_mfma_f32_16x16x32_bf16 v[88:91], v[204:207], v[180:183], v[88:91]
  ds_read_b128 v[164:167], v13 offset:5120
  v_mfma_f32_16x16x32_bf16 v[116:119], v[204:207], v[184:187], v[116:119]
  v_mfma_f32_16x16x32_bf16 v[36:39], v[208:211], v[172:175], v[36:39]
  ds_read_b128 v[168:171], v13 offset:6144
  v_mfma_f32_16x16x32_bf16 v[64:67], v[208:211], v[176:179], v[64:67]
  v_mfma_f32_16x16x32_bf16 v[92:95], v[208:211], v[180:183], v[92:95]
  v_mfma_f32_16x16x32_bf16 v[120:123], v[208:211], v[184:187], v[120:123]
  v_mfma_f32_16x16x32_bf16 v[40:43], v[212:215], v[172:175], v[40:43]
  v_mfma_f32_16x16x32_bf16 v[68:71], v[212:215], v[176:179], v[68:71]
  s_add_u32 s23, s23, 1
  s_cmp_lt_u32 s23, 13
  v_mfma_f32_16x16x32_bf16 v[96:99], v[212:215], v[180:183], v[96:99]
  v_mfma_f32_16x16x32_bf16 v[124:127], v[212:215], v[184:187], v[124:127]
  s_cbranch_scc1 L_loop
  s_waitcnt lgkmcnt(0)
  v_mfma_f32_16x16x32_bf16 v[32:35], v[160:163], v[128:131], v[32:35]
  ds_read_b128 v[172:175], v12 offset:0
  v_mfma_f32_16x16x32_bf16 v[60:63], v[160:163], v[132:135], v[60:63]
  ds_read_b128 v[176:179], v12 offset:2048
  v_mfma_f32_16x16x32_bf16 v[88:91], v[160:163], v[136:139], v[88:91]
  ds_read_b128 v[180:183], v12 offset:4096
  v_mfma_f32_16x16x32_bf16 v[116:119], v[160:163], v[140:143], v[116:119]
  ds_read_b128 v[184:187], v12 offset:6144
  v_mfma_f32_16x16x32_bf16 v[36:39], v[164:167], v[128:131], v[36:39]
  ds_read_b128 v[204:207], v13 offset:11264
  v_mfma_f32_16x16x32_bf16 v[64:67], v[164:167], v[132:135], v[64:67]
  ds_read_b128 v[208:211], v13 offset:12288
  v_mfma_f32_16x16x32_bf16 v[92:95], v[164:167], v[136:139], v[92:95]
  ds_read_b128 v[212:215], v13 offset:13312
  v_mfma_f32_16x16x32_bf16 v[120:123], v[164:167], v[140:143], v[120:123]
  v_mfma_f32_16x16x32_bf16 v[40:43], v[168:171], v[128:131], v[40:43]
  v_mfma_f32_16x16x32_bf16 v[68:71], v[168:171], v[132:135], v[68:71]
  v_mfma_f32_16x16x32_bf16 v[96:99], v[168:171], v[136:139], v[96:99]
  v_mfma_f32_16x16x32_bf16 v[124:127], v[168:171], v[140:143], v[124:127]
  s_waitcnt lgkmcnt(0)
  s_barrier
  v_mfma_f32_16x16x32_bf16 v[32:35], v[204:207], v[172:175], v[32:35]
  ds_read_b128 v[128:131], v216 offset:0
  v_mfma_f32_16x16x32_bf16 v[60:63], v[204:207], v[176:179], v[60:63]
  ds_read_b128 v[132:135], v216 offset:2048
  v_mfma_f32_16x16x32_bf16 v[88:91], v[204:207], v[180:183], v[88:91]
  ds_read_b128 v[136:139], v216 offset:4096
  v_mfma_f32_16x16x32_bf16 v[116:119], v[204:207], v[184:187], v[116:119]
  ds_read_b128 v[140:143], v216 offset:6144
  v_mfma_f32_16x16x32_bf16 v[36:39], v[208:211], v[172:175], v[36:39]
  ds_read_b128 v[160:163], v218 offset:4096
  v_mfma_f32_16x16x32_bf16 v[64:67], v[208:211], v[176:179], v[64:67]
  ds_read_b128 v[164:167], v218 offset:5120
  v_mfma_f32_16x16x32_bf16 v[92:95], v[208:211], v[180:183], v[92:95]
  ds_read_b128 v[168:171], v218 offset:6144
  v_mfma_f32_16x16x32_bf16 v[120:123], v[208:211], v[184:187], v[120:123]
  v_mfma_f32_16x16x32_bf16 v[40:43], v[212:215], v[172:175], v[40:43]
  v_mfma_f32_16x16x32_bf16 v[68:71], v[212:215], v[176:179], v[68:71]
  v_mfma_f32_16x16x32_bf16 v[96:99], v[212:215], v[180:183], v[96:99]
  v_mfma_f32_16x16x32_bf16 v[124:127], v[212:215], v[184:187], v[124:127]
  s_waitcnt lgkmcnt(0)
  v_mfma_f32_16x16x32_bf16 v[32:35], v[160:163], v[128:131], v[32:35]
  ds_read_b128 v[172:175], v217 offset:0
  v_mfma_f32_16x16x32_bf16 v[60:63], v[160:163], v[132:135], v[60:63]
  ds_read_b128 v[176:179], v217 offset:2048
  v_mfma_f32_16x16x32_bf16 v[88:91], v[160:163], v[136:139], v[88:91]
  ds_read_b128 v[180:183], v217 offset:4096
  v_mfma_f32_16x16x32_bf16 v[116:119], v[160:163], v[140:143], v[116:119]
  ds_read_b128 v[184:187], v217 offset:6144
  v_mfma_f32_16x16x32_bf16 v[36:39], v[164:167], v[128:131], v[36:39]
  ds_read_b128 v[204:207], v218 offset:11264
  v_mfma_f32_16x16x32_bf16 v[64:67], v[164:167], v[132:135], v[64:67]
  ds_read_b128 v[208:211], v218 offset:12288
  v_mfma_f32_16x16x32_bf16 v[92:95], v[164:167], v[136:139], v[92:95]
  ds_read_b128 v[212:215], v218 offset:13312
  v_mfma_f32_16x16x32_bf16 v[120:123], v[164:167], v[140:143], v[120:123]
  v_mfma_f32_16x16x32_bf16 v[40:43], v[168:171], v[128:131], v[40:43]
  v_mfma_f32_16x16x32_bf16 v[68:71], v[168:171], v[132:135], v[68:71]
  v_mfma_f32_16x16x32_bf16 v[96:99], v[168:171], v[136:139], v[96:99]
  v_mfma_f32_16x16x32_bf16 v[124:127], v[168:171], v[140:143], v[124:127]
  s_waitcnt lgkmcnt(0)
  s_barrier
  v_mfma_f32_16x16x32_bf16 v[32:35], v[204:207], v[172:175], v[32:35]
  ds_read_b128 v[128:131], v8 offset:0
  v_mfma_f32_16x16x32_bf16 v[60:63], v[204:207], v[176:179], v[60:63]
  ds_read_b128 v[132:135], v8 offset:2048
  v_mfma_f32_16x16x32_bf16 v[88:91], v[204:207], v[180:183], v[88:91]
  ds_read_b128 v[136:139], v8 offset:4096
  v_mfma_f32_16x16x32_bf16 v[116:119], v[204:207], v[184:187], v[116:119]
  ds_read_b128 v[140:143], v8 offset:6144
  v_mfma_f32_16x16x32_bf16 v[36:39], v[208:211], v[172:175], v[36:39]
  ds_read_b128 v[160:163], v10 offset:4096
  v_mfma_f32_16x16x32_bf16 v[64:67], v[208:211], v[176:179], v[64:67]
  ds_read_b128 v[164:167], v10 offset:5120
  v_mfma_f32_16x16x32_bf16 v[92:95], v[208:211], v[180:183], v[92:95]
  ds_read_b128 v[168:171], v10 offset:6144
  v_mfma_f32_16x16x32_bf16 v[120:123], v[208:211], v[184:187], v[120:123]
  v_mfma_f32_16x16x32_bf16 v[40:43], v[212:215], v[172:175], v[40:43]
  v_mfma_f32_16x16x32_bf16 v[68:71], v[212:215], v[176:179], v[68:71]
  v_mfma_f32_16x16x32_bf16 v[96:99], v[212:215], v[180:183], v[96:99]
  v_mfma_f32_16x16x32_bf16 v[124:127], v[212:215], v[184:187], v[124:127]
  s_waitcnt lgkmcnt(0)
  v_mfma_f32_16x16x32_bf16 v[32:35], v[160:163], v[128:131], v[32:35]
  ds_read_b128 v[172:175], v9 offset:0
  v_mfma_f32_16x16x32_bf16 v[60:63], v[160:163], v[132:135], v[60:63]
  ds_read_b128 v[176:179], v9 offset:2048
  v_mfma_f32_16x16x32_bf16 v[88:91], v[160:163], v[136:139], v[88:91]
  ds_read_b128 v[180:183], v9 offset:4096
  v_mfma_f32_16x16x32_bf16 v[116:119], v[160:163], v[140:143], v[116:119]
  ds_read_b128 v[184:187], v9 offset:6144
  v_mfma_f32_16x16x32_bf16 v[36:39], v[164:167], v[128:131], v[36:39]
  ds_read_b128 v[204:207], v10 offset:11264
  v_mfma_f32_16x16x32_bf16 v[64:67], v[164:167], v[132:135], v[64:67]
  ds_read_b128 v[208:211], v10 offset:12288
  v_mfma_f32_16x16x32_bf16 v[92:95], v[164:167], v[136:139], v[92:95]
  ds_read_b128 v[212:215], v10 offset:13312
  v_mfma_f32_16x16x32_bf16 v[120:123], v[164:167], v[140:143], v[120:123]
  v_mfma_f32_16x16x32_bf16 v[40:43], v[168:171], v[128:131], v[40:43]
  v_mfma_f32_16x16x32_bf16 v[68:71], v[168:171], v[132:135], v[68:71]
  v_mfma_f32_16x16x32_bf16 v[96:99], v[168:171], v[136:139], v[96:99]
  v_mfma_f32_16x16x32_bf16 v[124:127], v[168:171], v[140:143], v[124:127]
  s_waitcnt lgkmcnt(0)
  s_barrier
  v_mfma_f32_16x16x32_bf16 v[32:35], v[204:207], v[172:175], v[32:35]
  ds_read_b128 v[128:131], v11 offset:0
  v_mfma_f32_16x16x32_bf16 v[36:39], v[208:211], v[172:175], v[36:39]
  ds_read_b128 v[132:135], v11 offset:2048
  v_mfma_f32_16x16x32_bf16 v[40:43], v[212:215], v[172:175], v[40:43]
  ds_read_b128 v[136:139], v11 offset:4096
  v_mfma_f32_16x16x32_bf16 v[60:63], v[204:207], v[176:179], v[60:63]
  ds_read_b128 v[140:143], v11 offset:6144
  v_mfma_f32_16x16x32_bf16 v[64:67], v[208:211], v[176:179], v[64:67]
  ds_read_b128 v[144:147], v13 offset:0
  v_mfma_f32_16x16x32_bf16 v[68:71], v[212:215], v[176:179], v[68:71]
  ds_read_b128 v[148:151], v13 offset:1024
  v_mfma_f32_16x16x32_bf16 v[88:91], v[204:207], v[180:183], v[88:91]
  ds_read_b128 v[152:155], v13 offset:2048
  v_mfma_f32_16x16x32_bf16 v[92:95], v[208:211], v[180:183], v[92:95]
  ds_read_b128 v[156:159], v13 offset:3072
  v_mfma_f32_16x16x32_bf16 v[96:99], v[212:215], v[180:183], v[96:99]
  v_mfma_f32_16x16x32_bf16 v[116:119], v[204:207], v[184:187], v[116:119]
  v_mfma_f32_16x16x32_bf16 v[120:123], v[208:211], v[184:187], v[120:123]
  v_mfma_f32_16x16x32_bf16 v[124:127], v[212:215], v[184:187], v[124:127]
  s_waitcnt lgkmcnt(0)
  v_mfma_f32_16x16x32_bf16 v[16:19], v[144:147], v[128:131], v[16:19]
  ds_read_b128 v[172:175], v12 offset:0
  v_cvt_pk_bf16_f32 v226, v32, v36
  v_mfma_f32_16x16x32_bf16 v[44:47], v[144:147], v[132:135], v[44:47]
  ds_read_b128 v[176:179], v12 offset:2048
  v_cvt_pk_bf16_f32 v227, v33, v37
  v_mfma_f32_16x16x32_bf16 v[72:75], v[144:147], v[136:139], v[72:75]
  ds_read_b128 v[180:183], v12 offset:4096
  v_cvt_pk_bf16_f32 v228, v34, v38
  v_mfma_f32_16x16x32_bf16 v[100:103], v[144:147], v[140:143], v[100:103]
  ds_read_b128 v[184:187], v12 offset:6144
  v_cvt_pk_bf16_f32 v229, v35, v39
  v_mfma_f32_16x16x32_bf16 v[20:23], v[148:151], v[128:131], v[20:23]
  ds_read_b128 v[188:191], v13 offset:7168
  ds_write_b128 v219, v[226:229] offset:0
  v_mfma_f32_16x16x32_bf16 v[48:51], v[148:151], v[132:135], v[48:51]
  ds_read_b128 v[192:195], v13 offset:8192
  v_cvt_pk_bf16_f32 v230, v40, v41
  v_mfma_f32_16x16x32_bf16 v[76:79], v[148:151], v[136:139], v[76:79]
  ds_read_b128 v[196:199], v13 offset:9216
  v_cvt_pk_bf16_f32 v231, v42, v43
  v_mfma_f32_16x16x32_bf16 v[104:107], v[148:151], v[140:143], v[104:107]
  ds_read_b128 v[200:203], v13 offset:10240
  ds_write_b64 v224, v[230:231] offset:64
  v_mfma_f32_16x16x32_bf16 v[24:27], v[152:155], v[128:131], v[24:27]
  v_cvt_pk_bf16_f32 v234, v60, v64
  v_cvt_pk_bf16_f32 v235, v61, v65
  v_mfma_f32_16x16x32_bf16 v[52:55], v[152:155], v[132:135], v[52:55]
  v_cvt_pk_bf16_f32 v236, v62, v66
  v_cvt_pk_bf16_f32 v237, v63, v67
  v_mfma_f32_16x16x32_bf16 v[80:83], v[152:155], v[136:139], v[80:83]
  ds_write_b128 v219, v[234:237] offset:1792
  v_cvt_pk_bf16_f32 v238, v68, v69
  v_mfma_f32_16x16x32_bf16 v[108:111], v[152:155], v[140:143], v[108:111]
  v_cvt_pk_bf16_f32 v239, v70, v71
  ds_write_b64 v224, v[238:239] offset:1856
  v_mfma_f32_16x16x32_bf16 v[28:31], v[156:159], v[128:131], v[28:31]
  v_mfma_f32_16x16x32_bf16 v[56:59], v[156:159], v[132:135], v[56:59]
  v_mfma_f32_16x16x32_bf16 v[84:87], v[156:159], v[136:139], v[84:87]
  v_mfma_f32_16x16x32_bf16 v[112:115], v[156:159], v[140:143], v[112:115]
  s_waitcnt lgkmcnt(0)
  v_mfma_f32_16x16x32_bf16 v[16:19], v[188:191], v[172:175], v[16:19]
  ds_read_b128 v[128:131], v216 offset:0
  v_cvt_pk_bf16_f32 v226, v88, v92
  v_mfma_f32_16x16x32_bf16 v[44:47], v[188:191], v[176:179], v[44:47]
  ds_read_b128 v[132:135], v216 offset:2048
  v_cvt_pk_bf16_f32 v227, v89, v93
  v_mfma_f32_16x16x32_bf16 v[72:75], v[188:191], v[180:183], v[72:75]
  ds_read_b128 v[136:139], v216 offset:4096
  v_cvt_pk_bf16_f32 v228, v90, v94
  v_mfma_f32_16x16x32_bf16 v[100:103], v[188:191], v[184:187], v[100:103]
  ds_read_b128 v[140:143], v216 offset:6144
  v_cvt_pk_bf16_f32 v229, v91, v95
  v_mfma_f32_16x16x32_bf16 v[20:23], v[192:195], v[172:175], v[20:23]
  ds_read_b128 v[144:147], v218 offset:0
  ds_write_b128 v219, v[226:229] offset:3584
  v_mfma_f32_16x16x32_bf16 v[48:51], v[192:195], v[176:179], v[48:51]
  ds_read_b128 v[148:151], v218 offset:1024
  v_cvt_pk_bf16_f32 v230, v96, v97
  v_mfma_f32_16x16x32_bf16 v[76:79], v[192:195], v[180:183], v[76:79]
  ds_read_b128 v[152:155], v218 offset:2048
  v_cvt_pk_bf16_f32 v231, v98, v99
  v_mfma_f32_16x16x32_bf16 v[104:107], v[192:195], v[184:187], v[104:107]
  ds_read_b128 v[156:159], v218 offset:3072
  ds_write_b64 v224, v[230:231] offset:3648
  v_mfma_f32_16x16x32_bf16 v[24:27], v[196:199], v[172:175], v[24:27]
  v_cvt_pk_bf16_f32 v234, v116, v120
  v_cvt_pk_bf16_f32 v235, v117, v121
  v_mfma_f32_16x16x32_bf16 v[52:55], v[196:199], v[176:179], v[52:55]
  v_cvt_pk_bf16_f32 v236, v118, v122
  v_cvt_pk_bf16_f32 v237, v119, v123
  v_mfma_f32_16x16x32_bf16 v[80:83], v[196:199], v[180:183], v[80:83]
  ds_write_b128 v220, v[234:237] offset:0
  v_cvt_pk_bf16_f32 v238, v124, v125
  v_mfma_f32_16x16x32_bf16 v[108:111], v[196:199], v[184:187], v[108:111]
  v_cvt_pk_bf16_f32 v239, v126, v127
  ds_write_b64 v225, v[238:239] offset:64
  v_mfma_f32_16x16x32_bf16 v[28:31], v[200:203], v[172:175], v[28:31]
  v_mfma_f32_16x16x32_bf16 v[56:59], v[200:203], v[176:179], v[56:59]
  v_mfma_f32_16x16x32_bf16 v[84:87], v[200:203], v[180:183], v[84:87]
  v_mfma_f32_16x16x32_bf16 v[112:115], v[200:203], v[184:187], v[112:115]
  s_waitcnt lgkmcnt(0)
  s_barrier
  v_mfma_f32_16x16x32_bf16 v[16:19], v[144:147], v[128:131], v[16:19]
  ds_read_b128 v[172:175], v217 offset:0
  v_mfma_f32_16x16x32_bf16 v[44:47], v[144:147], v[132:135], v[44:47]
  ds_read_b128 v[176:179], v217 offset:2048
  v_mfma_f32_16x16x32_bf16 v[72:75], v[144:147], v[136:139], v[72:75]
  ds_read_b128 v[180:183], v217 offset:4096
  v_mfma_f32_16x16x32_bf16 v[100:103], v[144:147], v[140:143], v[100:103]
  ds_read_b128 v[184:187], v217 offset:6144
  v_mfma_f32_16x16x32_bf16 v[20:23], v[148:151], v[128:131], v[20:23]
  ds_read_b128 v[188:191], v218 offset:7168
  v_mfma_f32_16x16x32_bf16 v[48:51], v[148:151], v[132:135], v[48:51]
  ds_read_b128 v[192:195], v218 offset:8192
  v_mfma_f32_16x16x32_bf16 v[76:79], v[148:151], v[136:139], v[76:79]
  ds_read_b128 v[196:199], v218 offset:9216
  v_mfma_f32_16x16x32_bf16 v[104:107], v[148:151], v[140:143], v[104:107]
  ds_read_b128 v[200:203], v218 offset:10240
  v_mfma_f32_16x16x32_bf16 v[24:27], v[152:155], v[128:131], v[24:27]
  v_mfma_f32_16x16x32_bf16 v[52:55], v[152:155], v[132:135], v[52:55]
  v_mfma_f32_16x16x32_bf16 v[80:83], v[152:155], v[136:139], v[80:83]
  v_mfma_f32_16x16x32_bf16 v[108:111], v[152:155], v[140:143], v[108:111]
  v_mfma_f32_16x16x32_bf16 v[28:31], v[156:159], v[128:131], v[28:31]
  v_mfma_f32_16x16x32_bf16 v[56:59], v[156:159], v[132:135], v[56:59]
  v_mfma_f32_16x16x32_bf16 v[84:87], v[156:159], v[136:139], v[84:87]
  v_mfma_f32_16x16x32_bf16 v[112:115], v[156:159], v[140:143], v[112:115]
  s_waitcnt lgkmcnt(0)
  v_mfma_f32_16x16x32_bf16 v[16:19], v[188:191], v[172:175], v[16:19]
  ds_read_b128 v[128:131], v8 offset:0
  v_mfma_f32_16x16x32_bf16 v[44:47], v[188:191], v[176:179], v[44:47]
  ds_read_b128 v[132:135], v8 offset:2048
  v_mfma_f32_16x16x32_bf16 v[72:75], v[188:191], v[180:183], v[72:75]
  ds_read_b128 v[136:139], v8 offset:4096
  v_mfma_f32_16x16x32_bf16 v[100:103], v[188:191], v[184:187], v[100:103]
  ds_read_b128 v[140:143], v8 offset:6144
  v_mfma_f32_16x16x32_bf16 v[20:23], v[192:195], v[172:175], v[20:23]
  ds_read_b128 v[144:147], v10 offset:0
  v_mfma_f32_16x16x32_bf16 v[48:51], v[192:195], v[176:179], v[48:51]
  ds_read_b128 v[148:151], v10 offset:1024
  v_mfma_f32_16x16x32_bf16 v[76:79], v[192:195], v[180:183], v[76:79]
  ds_read_b128 v[152:155], v10 offset:2048
  v_mfma_f32_16x16x32_bf16 v[104:107], v[192:195], v[184:187], v[104:107]
  ds_read_b128 v[156:159], v10 offset:3072
  v_mfma_f32_16x16x32_bf16 v[24:27], v[196:199], v[172:175], v[24:27]
  v_mfma_f32_16x16x32_bf16 v[52:55], v[196:199], v[176:179], v[52:55]
  v_mfma_f32_16x16x32_bf16 v[80:83], v[196:199], v[180:183], v[80:83]
  v_mfma_f32_16x16x32_bf16 v[108:111], v[196:199], v[184:187], v[108:111]
  v_mfma_f32_16x16x32_bf16 v[28:31], v[200:203], v[172:175], v[28:31]
  v_mfma_f32_16x16x32_bf16 v[56:59], v[200:203], v[176:179], v[56:59]
  v_mfma_f32_16x16x32_bf16 v[84:87], v[200:203], v[180:183], v[84:87]
  v_mfma_f32_16x16x32_bf16 v[112:115], v[200:203], v[184:187], v[112:115]
  s_waitcnt lgkmcnt(0)
  v_mfma_f32_16x16x32_bf16 v[16:19], v[144:147], v[128:131], v[16:19]
  ds_read_b128 v[172:175], v9 offset:0
  v_mfma_f32_16x16x32_bf16 v[44:47], v[144:147], v[132:135], v[44:47]
  ds_read_b128 v[176:179], v9 offset:2048
  v_mfma_f32_16x16x32_bf16 v[72:75], v[144:147], v[136:139], v[72:75]
  ds_read_b128 v[180:183], v9 offset:4096
  v_mfma_f32_16x16x32_bf16 v[100:103], v[144:147], v[140:143], v[100:103]
  ds_read_b128 v[184:187], v9 offset:6144
  v_mfma_f32_16x16x32_bf16 v[20:23], v[148:151], v[128:131], v[20:23]
  ds_read_b128 v[188:191], v10 offset:7168
  v_mfma_f32_16x16x32_bf16 v[48:51], v[148:151], v[132:135], v[48:51]
  ds_read_b128 v[192:195], v10 offset:8192
  v_mfma_f32_16x16x32_bf16 v[76:79], v[148:151], v[136:139], v[76:79]
  ds_read_b128 v[196:199], v10 offset:9216
  v_mfma_f32_16x16x32_bf16 v[104:107], v[148:151], v[140:143], v[104:107]
  ds_read_b128 v[200:203], v10 offset:10240
  v_mfma_f32_16x16x32_bf16 v[24:27], v[152:155], v[128:131], v[24:27]
  v_mfma_f32_16x16x32_bf16 v[52:55], v[152:155], v[132:135], v[52:55]
  v_mfma_f32_16x16x32_bf16 v[80:83], v[152:155], v[136:139], v[80:83]
  v_mfma_f32_16x16x32_bf16 v[108:111], v[152:155], v[140:143], v[108:111]
  v_mfma_f32_16x16x32_bf16 v[28:31], v[156:159], v[128:131], v[28:31]
  v_mfma_f32_16x16x32_bf16 v[56:59], v[156:159], v[132:135], v[56:59]
  v_mfma_f32_16x16x32_bf16 v[84:87], v[156:159], v[136:139], v[84:87]
  v_mfma_f32_16x16x32_bf16 v[112:115], v[156:159], v[140:143], v[112:115]
  s_waitcnt lgkmcnt(0)
  v_mfma_f32_16x16x32_bf16 v[16:19], v[188:191], v[172:175], v[16:19]
  v_mfma_f32_16x16x32_bf16 v[20:23], v[192:195], v[172:175], v[20:23]
  v_mfma_f32_16x16x32_bf16 v[24:27], v[196:199], v[172:175], v[24:27]
  v_mfma_f32_16x16x32_bf16 v[28:31], v[200:203], v[172:175], v[28:31]
  v_mfma_f32_16x16x32_bf16 v[44:47], v[188:191], v[176:179], v[44:47]
  v_mfma_f32_16x16x32_bf16 v[48:51], v[192:195], v[176:179], v[48:51]
  v_mfma_f32_16x16x32_bf16 v[52:55], v[196:199], v[176:179], v[52:55]
  v_mfma_f32_16x16x32_bf16 v[56:59], v[200:203], v[176:179], v[56:59]
  v_cvt_pk_bf16_f32 v226, v16, v20
  v_cvt_pk_bf16_f32 v227, v24, v28
  v_mfma_f32_16x16x32_bf16 v[72:75], v[188:191], v[180:183], v[72:75]
  v_cvt_pk_bf16_f32 v228, v17, v21
  v_cvt_pk_bf16_f32 v229, v25, v29
  v_mfma_f32_16x16x32_bf16 v[76:79], v[192:195], v[180:183], v[76:79]
  ds_write_b128 v221, v[226:229] offset:0
  v_cvt_pk_bf16_f32 v230, v18, v22
  v_mfma_f32_16x16x32_bf16 v[80:83], v[196:199], v[180:183], v[80:83]
  v_cvt_pk_bf16_f32 v231, v26, v30
  v_cvt_pk_bf16_f32 v232, v19, v23
  v_mfma_f32_16x16x32_bf16 v[84:87], v[200:203], v[180:183], v[84:87]
  v_cvt_pk_bf16_f32 v233, v27, v31
  ds_write_b128 v221, v[230:233] offset:16
  v_mfma_f32_16x16x32_bf16 v[100:103], v[188:191], v[184:187], v[100:103]
  v_cvt_pk_bf16_f32 v234, v44, v48
  v_cvt_pk_bf16_f32 v235, v52, v56
  v_mfma_f32_16x16x32_bf16 v[104:107], v[192:195], v[184:187], v[104:107]
  v_cvt_pk_bf16_f32 v236, v45, v49
  v_cvt_pk_bf16_f32 v237, v53, v57
  v_mfma_f32_16x16x32_bf16 v[108:111], v[196:199], v[184:187], v[108:111]
  ds_write_b128 v221, v[234:237] offset:2304
  v_cvt_pk_bf16_f32 v238, v46, v50
  v_mfma_f32_16x16x32_bf16 v[112:115], v[200:203], v[184:187], v[112:115]
  v_cvt_pk_bf16_f32 v239, v54, v58
  v_cvt_pk_bf16_f32 v240, v47, v51
  v_cvt_pk_bf16_f32 v241, v55, v59
  ds_write_b128 v221, v[238:241] offset:2320
  s_waitcnt lgkmcnt(0)
  s_barrier
  v_cvt_pk_bf16_f32 v226, v72, v76
  v_cvt_pk_bf16_f32 v227, v80, v84
  v_cvt_pk_bf16_f32 v228, v73, v77
  v_cvt_pk_bf16_f32 v229, v81, v85
  ds_write_b128 v221, v[226:229] offset:4608
  v_cvt_pk_bf16_f32 v230, v74, v78
  v_cvt_pk_bf16_f32 v231, v82, v86
  v_cvt_pk_bf16_f32 v232, v75, v79
  v_cvt_pk_bf16_f32 v233, v83, v87
  ds_write_b128 v221, v[230:233] offset:4624
  v_cvt_pk_bf16_f32 v234, v100, v104
  v_cvt_pk_bf16_f32 v235, v108, v112
  v_cvt_pk_bf16_f32 v236, v101, v105
  v_cvt_pk_bf16_f32 v237, v109, v113
  ds_write_b128 v221, v[234:237] offset:6912
  v_cvt_pk_bf16_f32 v238, v102, v106
  v_cvt_pk_bf16_f32 v239, v110, v114
  v_cvt_pk_bf16_f32 v240, v103, v107
  v_cvt_pk_bf16_f32 v241, v111, v115
  ds_write_b128 v221, v[238:241] offset:6928
  ds_read_b128 v[128:131], v222 offset:4608
  ds_read_b128 v[132:135], v222 offset:5760
  ds_read_b128 v[136:139], v222 offset:6912
  ds_read_b128 v[140:143], v222 offset:8064
  s_waitcnt lgkmcnt(3)
  buffer_store_dwordx4 v[128:131], v223, s[44:47], s9 offen sc1
  s_add_u32 s9, s9, 57344
  s_waitcnt lgkmcnt(2)
  buffer_store_dwordx4 v[132:135], v223, s[44:47], s9 offen sc1
  s_add_u32 s9, s9, 57344
  s_waitcnt lgkmcnt(1)
  buffer_store_dwordx4 v[136:139], v223, s[44:47], s9 offen sc1
  s_add_u32 s9, s9, 57344
  s_waitcnt lgkmcnt(0)
  buffer_store_dwordx4 v[140:143], v223, s[44:47], s9 offen sc1
  s_endpgm
L_helper:
  s_setprio 2
  s_mov_b32 s0, 0x3eca8642
  s_mov_b32 s1, 0xfdb975
  s_mov_b32 s23, 2
  s_mov_b32 s22, 94208
  s_cmp_eq_u32 s21, 3
  s_cbranch_scc1 L_wloader
  v_lshrrev_b32 v1, 3, v2
  v_and_b32 v16, 7, v2
  v_xor_b32 v16, v16, v1
  v_lshlrev_b32 v16, 4, v16
  v_lshl_add_u32 v16, v1, 11, v16
  s_mul_i32 s12, s21, 11
  s_lshl_b32 s5, s12, 14
  s_lshl_b32 s13, s18, 19
  s_add_u32 s5, s5, s13
  v_add_u32 v16, s5, v16
  v_add_u32 v17, 15360, v16
  v_add_u32 v18, 30720, v16
  v_add_u32 v19, 46080, v16
  v_add_u32 v20, 65536, v16
  v_add_u32 v21, 80896, v16
  v_add_u32 v22, 96256, v16
  v_add_u32 v23, 111616, v16
  v_add_u32 v24, 131072, v16
  v_add_u32 v25, 146432, v16
  s_lshl_b32 s12, s12, 10
  s_add_u32 s15, s12, 10240
  s_cmp_eq_u32 s21, 2
  s_cselect_b32 s14, 0, -1
  s_cselect_b32 s15, 141312, s15
  s_cselect_b32 s5, 0x40000000, 163840
  v_add_u32 v26, s5, v16
  s_lshl_b32 s5, s19, 14
  s_add_u32 s13, s13, s5
  s_mul_i32 s5, s21, 6144
  s_add_u32 s13, s13, s5
  s_barrier
  s_call_b64 s[60:61], L_produce
  s_waitcnt lgkmcnt(0)
  s_barrier
  s_add_u32 s17, s0, s16
  s_and_b32 s17, s17, 15
  s_add_u32 m0, s22, s12
  s_lshl_b32 s17, s17, 7
  buffer_load_dwordx4 v16, s[24:27], s17 offen offset:0 lds
  buffer_load_dwordx4 v17, s[24:27], s17 offen offset:1024 lds
  buffer_load_dwordx4 v18, s[24:27], s17 offen offset:2048 lds
  buffer_load_dwordx4 v19, s[24:27], s17 offen offset:3072 lds
  s_add_u32 m0, m0, 4096
  s_nop 0
  buffer_load_dwordx4 v20, s[24:27], s17 offen offset:0 lds
  buffer_load_dwordx4 v21, s[24:27], s17 offen offset:1024 lds
  buffer_load_dwordx4 v22, s[24:27], s17 offen offset:2048 lds
  buffer_load_dwordx4 v23, s[24:27], s17 offen offset:3072 lds
  s_add_u32 m0, m0, 4096
  s_nop 0
  buffer_load_dwordx4 v24, s[24:27], s17 offen offset:0 lds
  buffer_load_dwordx4 v25, s[24:27], s17 offen offset:1024 lds
  s_and_b32 s5, s22, s14
  s_add_u32 m0, s5, s15
  s_nop 0
  buffer_load_dwordx4 v26, s[24:27], s17 offen offset:0 lds
  s_lshr_b64 s[0:1], s[0:1], 4
  s_add_u32 s23, s23, 1
  s_add_u32 s22, s22, 47104
  s_cmp_eq_u32 s22, 141312
  s_cselect_b32 s22, 0, s22
  s_barrier
  s_lshr_b64 s[34:35], s[0:1], 8
  s_add_u32 s8, s34, s16
  s_and_b32 s8, s8, 15
  s_lshl_b32 s8, s8, 7
  s_add_u32 s8, s8, s13
  s_buffer_load_dword s3, s[24:27], s8 offset:0
  s_buffer_load_dword s3, s[24:27], s8 offset:64
  s_buffer_load_dword s3, s[24:27], s8 offset:2048
  s_buffer_load_dword s3, s[24:27], s8 offset:2112
  s_buffer_load_dword s3, s[24:27], s8 offset:4096
  s_buffer_load_dword s3, s[24:27], s8 offset:4160
  s_add_u32 s17, s0, s16
  s_and_b32 s17, s17, 15
  s_add_u32 m0, s22, s12
  s_lshl_b32 s17, s17, 7
  buffer_load_dwordx4 v16, s[24:27], s17 offen offset:0 lds
  buffer_load_dwordx4 v17, s[24:27], s17 offen offset:1024 lds
  buffer_load_dwordx4 v18, s[24:27], s17 offen offset:2048 lds
  buffer_load_dwordx4 v19, s[24:27], s17 offen offset:3072 lds
  s_add_u32 m0, m0, 4096
  s_nop 0
  buffer_load_dwordx4 v20, s[24:27], s17 offen offset:0 lds
  buffer_load_dwordx4 v21, s[24:27], s17 offen offset:1024 lds
  buffer_load_dwordx4 v22, s[24:27], s17 offen offset:2048 lds
  buffer_load_dwordx4 v23, s[24:27], s17 offen offset:3072 lds
  s_add_u32 m0, m0, 4096
  s_nop 0
  buffer_load_dwordx4 v24, s[24:27], s17 offen offset:0 lds
  buffer_load_dwordx4 v25, s[24:27], s17 offen offset:1024 lds
  s_and_b32 s5, s22, s14
  s_add_u32 m0, s5, s15
  s_nop 0
  buffer_load_dwordx4 v26, s[24:27], s17 offen offset:0 lds
  s_lshr_b64 s[0:1], s[0:1], 4
  s_add_u32 s23, s23, 1
  s_add_u32 s22, s22, 47104
  s_cmp_eq_u32 s22, 141312
  s_cselect_b32 s22, 0, s22
  s_waitcnt vmcnt(11)
  s_barrier
  s_mov_b32 s33, s7
  s_lshr_b64 s[34:35], s[0:1], 8
  s_add_u32 s8, s34, s16
  s_and_b32 s8, s8, 15
  s_lshl_b32 s8, s8, 7
  s_add_u32 s8, s8, s13
  s_buffer_load_dword s3, s[24:27], s8 offset:0
  s_buffer_load_dword s3, s[24:27], s8 offset:64
  s_buffer_load_dword s3, s[24:27], s8 offset:2048
  s_buffer_load_dword s3, s[24:27], s8 offset:2112
  s_buffer_load_dword s3, s[24:27], s8 offset:4096
  s_buffer_load_dword s3, s[24:27], s8 offset:4160
  s_add_u32 s17, s0, s16
  s_and_b32 s17, s17, 15
  s_add_u32 m0, s22, s12
  s_lshl_b32 s17, s17, 7
  buffer_load_dwordx4 v16, s[24:27], s17 offen offset:0 lds
  buffer_load_dwordx4 v17, s[24:27], s17 offen offset:1024 lds
  buffer_load_dwordx4 v18, s[24:27], s17 offen offset:2048 lds
  buffer_load_dwordx4 v19, s[24:27], s17 offen offset:3072 lds
  s_add_u32 m0, m0, 4096
  s_nop 0
  buffer_load_dwordx4 v20, s[24:27], s17 offen offset:0 lds
  buffer_load_dwordx4 v21, s[24:27], s17 offen offset:1024 lds
  buffer_load_dwordx4 v22, s[24:27], s17 offen offset:2048 lds
  buffer_load_dwordx4 v23, s[24:27], s17 offen offset:3072 lds
  s_add_u32 m0, m0, 4096
  s_nop 0
  buffer_load_dwordx4 v24, s[24:27], s17 offen offset:0 lds
  buffer_load_dwordx4 v25, s[24:27], s17 offen offset:1024 lds
  s_and_b32 s5, s22, s14
  s_add_u32 m0, s5, s15
  s_nop 0
  buffer_load_dwordx4 v26, s[24:27], s17 offen offset:0 lds
  s_lshr_b64 s[0:1], s[0:1], 4
  s_add_u32 s23, s23, 1
  s_add_u32 s22, s22, 47104
  s_cmp_eq_u32 s22, 141312
  s_cselect_b32 s22, 0, s22
  s_mov_b32 s7, s33
  buffer_store_dwordx4 v[168:171], v5, s[40:43], s7 offen offset:0 sc1
  buffer_store_dwordx4 v[172:175], v5, s[40:43], s7 offen offset:1024 sc1
  buffer_store_dwordx4 v[176:179], v5, s[40:43], s7 offen offset:2048 sc1
  s_cmp_eq_u32 s21, 2
  s_cbranch_scc1 L_ls3_0
  buffer_store_dwordx4 v[180:183], v5, s[40:43], s7 offen offset:3072 sc1
  s_waitcnt vmcnt(15)
  s_branch L_ls4_0
L_ls3_0:
  s_waitcnt vmcnt(14)
L_ls4_0:
  s_barrier
  s_lshr_b64 s[34:35], s[0:1], 8
  s_add_u32 s8, s34, s16
  s_and_b32 s8, s8, 15
  s_lshl_b32 s8, s8, 7
  s_add_u32 s8, s8, s13
  s_buffer_load_dword s3, s[24:27], s8 offset:0
  s_buffer_load_dword s3, s[24:27], s8 offset:64
  s_buffer_load_dword s3, s[24:27], s8 offset:2048
  s_buffer_load_dword s3, s[24:27], s8 offset:2112
  s_buffer_load_dword s3, s[24:27], s8 offset:4096
  s_buffer_load_dword s3, s[24:27], s8 offset:4160
  s_add_u32 s17, s0, s16
  s_and_b32 s17, s17, 15
  s_add_u32 m0, s22, s12
  s_lshl_b32 s17, s17, 7
  buffer_load_dwordx4 v16, s[24:27], s17 offen offset:0 lds
  buffer_load_dwordx4 v17, s[24:27], s17 offen offset:1024 lds
  buffer_load_dwordx4 v18, s[24:27], s17 offen offset:2048 lds
  buffer_load_dwordx4 v19, s[24:27], s17 offen offset:3072 lds
  s_add_u32 m0, m0, 4096
  s_nop 0
  buffer_load_dwordx4 v20, s[24:27], s17 offen offset:0 lds
  buffer_load_dwordx4 v21, s[24:27], s17 offen offset:1024 lds
  buffer_load_dwordx4 v22, s[24:27], s17 offen offset:2048 lds
  buffer_load_dwordx4 v23, s[24:27], s17 offen offset:3072 lds
  s_add_u32 m0, m0, 4096
  s_nop 0
  buffer_load_dwordx4 v24, s[24:27], s17 offen offset:0 lds
  buffer_load_dwordx4 v25, s[24:27], s17 offen offset:1024 lds
  s_and_b32 s5, s22, s14
  s_add_u32 m0, s5, s15
  s_nop 0
  buffer_load_dwordx4 v26, s[24:27], s17 offen offset:0 lds
  s_lshr_b64 s[0:1], s[0:1], 4
  s_add_u32 s23, s23, 1
  s_add_u32 s22, s22, 47104
  s_cmp_eq_u32 s22, 141312
  s_cselect_b32 s22, 0, s22
  s_waitcnt vmcnt(11)
  s_barrier
  s_lshr_b64 s[34:35], s[0:1], 8
  s_add_u32 s8, s34, s16
  s_and_b32 s8, s8, 15
  s_lshl_b32 s8, s8, 7
  s_add_u32 s8, s8, s13
  s_buffer_load_dword s3, s[24:27], s8 offset:0
  s_buffer_load_dword s3, s[24:27], s8 offset:64
  s_buffer_load_dword s3, s[24:27], s8 offset:2048
  s_buffer_load_dword s3, s[24:27], s8 offset:2112
  s_buffer_load_dword s3, s[24:27], s8 offset:4096
  s_buffer_load_dword s3, s[24:27], s8 offset:4160
  s_add_u32 s17, s0, s16
  s_and_b32 s17, s17, 15
  s_add_u32 m0, s22, s12
  s_lshl_b32 s17, s17, 7
  buffer_load_dwordx4 v16, s[24:27], s17 offen offset:0 lds
  buffer_load_dwordx4 v17, s[24:27], s17 offen offset:1024 lds
  buffer_load_dwordx4 v18, s[24:27], s17 offen offset:2048 lds
  buffer_load_dwordx4 v19, s[24:27], s17 offen offset:3072 lds
  s_add_u32 m0, m0, 4096
  s_nop 0
  buffer_load_dwordx4 v20, s[24:27], s17 offen offset:0 lds
  buffer_load_dwordx4 v21, s[24:27], s17 offen offset:1024 lds
  buffer_load_dwordx4 v22, s[24:27], s17 offen offset:2048 lds
  buffer_load_dwordx4 v23, s[24:27], s17 offen offset:3072 lds
  s_add_u32 m0, m0, 4096
  s_nop 0
  buffer_load_dwordx4 v24, s[24:27], s17 offen offset:0 lds
  buffer_load_dwordx4 v25, s[24:27], s17 offen offset:1024 lds
  s_and_b32 s5, s22, s14
  s_add_u32 m0, s5, s15
  s_nop 0
  buffer_load_dwordx4 v26, s[24:27], s17 offen offset:0 lds
  s_lshr_b64 s[0:1], s[0:1], 4
  s_add_u32 s23, s23, 1
  s_add_u32 s22, s22, 47104
  s_cmp_eq_u32 s22, 141312
  s_cselect_b32 s22, 0, s22
  s_mov_b64 exec, 1
  buffer_store_dwordx2 v[184:185], v186, s[40:43], 0 offen sc1
  s_mov_b64 exec, -1
  s_waitcnt vmcnt(12)
  s_barrier
  s_lshr_b64 s[34:35], s[0:1], 8
  s_add_u32 s8, s34, s16
  s_and_b32 s8, s8, 15
  s_lshl_b32 s8, s8, 7
  s_add_u32 s8, s8, s13
  s_buffer_load_dword s3, s[24:27], s8 offset:0
  s_buffer_load_dword s3, s[24:27], s8 offset:64
  s_buffer_load_dword s3, s[24:27], s8 offset:2048
  s_buffer_load_dword s3, s[24:27], s8 offset:2112
  s_buffer_load_dword s3, s[24:27], s8 offset:4096
  s_buffer_load_dword s3, s[24:27], s8 offset:4160
  s_add_u32 s17, s0, s16
  s_and_b32 s17, s17, 15
  s_add_u32 m0, s22, s12
  s_lshl_b32 s17, s17, 7
  buffer_load_dwordx4 v16, s[24:27], s17 offen offset:0 lds
  buffer_load_dwordx4 v17, s[24:27], s17 offen offset:1024 lds
  buffer_load_dwordx4 v18, s[24:27], s17 offen offset:2048 lds
  buffer_load_dwordx4 v19, s[24:27], s17 offen offset:3072 lds
  s_add_u32 m0, m0, 4096
  s_nop 0
  buffer_load_dwordx4 v20, s[24:27], s17 offen offset:0 lds
  buffer_load_dwordx4 v21, s[24:27], s17 offen offset:1024 lds
  buffer_load_dwordx4 v22, s[24:27], s17 offen offset:2048 lds
  buffer_load_dwordx4 v23, s[24:27], s17 offen offset:3072 lds
  s_add_u32 m0, m0, 4096
  s_nop 0
  buffer_load_dwordx4 v24, s[24:27], s17 offen offset:0 lds
  buffer_load_dwordx4 v25, s[24:27], s17 offen offset:1024 lds
  s_and_b32 s5, s22, s14
  s_add_u32 m0, s5, s15
  s_nop 0
  buffer_load_dwordx4 v26, s[24:27], s17 offen offset:0 lds
  s_lshr_b64 s[0:1], s[0:1], 4
  s_add_u32 s23, s23, 1
  s_add_u32 s22, s22, 47104
  s_cmp_eq_u32 s22, 141312
  s_cselect_b32 s22, 0, s22
  s_waitcnt vmcnt(12)
  s_barrier
L_x_loop:
  s_cmp_ge_u32 s23, 14
  s_cbranch_scc1 L_nowarm
  s_lshr_b64 s[34:35], s[0:1], 8
  s_add_u32 s8, s34, s16
  s_and_b32 s8, s8, 15
  s_lshl_b32 s8, s8, 7
  s_add_u32 s8, s8, s13
  s_buffer_load_dword s3, s[24:27], s8 offset:0
  s_buffer_load_dword s3, s[24:27], s8 offset:64
  s_buffer_load_dword s3, s[24:27], s8 offset:2048
  s_buffer_load_dword s3, s[24:27], s8 offset:2112
  s_buffer_load_dword s3, s[24:27], s8 offset:4096
  s_buffer_load_dword s3, s[24:27], s8 offset:4160
L_nowarm:
  s_add_u32 s17, s0, s16
  s_and_b32 s17, s17, 15
  s_add_u32 m0, s22, s12
  s_lshl_b32 s17, s17, 7
  buffer_load_dwordx4 v16, s[24:27], s17 offen offset:0 lds
  buffer_load_dwordx4 v17, s[24:27], s17 offen offset:1024 lds
  buffer_load_dwordx4 v18, s[24:27], s17 offen offset:2048 lds
  buffer_load_dwordx4 v19, s[24:27], s17 offen offset:3072 lds
  s_add_u32 m0, m0, 4096
  s_nop 0
  buffer_load_dwordx4 v20, s[24:27], s17 offen offset:0 lds
  buffer_load_dwordx4 v21, s[24:27], s17 offen offset:1024 lds
  buffer_load_dwordx4 v22, s[24:27], s17 offen offset:2048 lds
  buffer_load_dwordx4 v23, s[24:27], s17 offen offset:3072 lds
  s_add_u32 m0, m0, 4096
  s_nop 0
  buffer_load_dwordx4 v24, s[24:27], s17 offen offset:0 lds
  buffer_load_dwordx4 v25, s[24:27], s17 offen offset:1024 lds
  s_and_b32 s5, s22, s14
  s_add_u32 m0, s5, s15
  s_nop 0
  buffer_load_dwordx4 v26, s[24:27], s17 offen offset:0 lds
  s_lshr_b64 s[0:1], s[0:1], 4
  s_add_u32 s23, s23, 1
  s_add_u32 s22, s22, 47104
  s_cmp_eq_u32 s22, 141312
  s_cselect_b32 s22, 0, s22
  s_waitcnt vmcnt(11)
  s_barrier
  s_cmp_lt_u32 s23, 16
  s_cbranch_scc1 L_x_loop
  s_branch L_htail
L_wloader:
  v_add_u32 v16, 4096, v5
  v_add_u32 v17, 8192, v5
  v_add_u32 v18, 12288, v5
  s_mov_b32 s62, 64
  s_barrier
  s_call_b64 s[60:61], L_produce
  s_waitcnt lgkmcnt(0)
  s_barrier
  s_barrier
  buffer_load_dwordx2 v[22:23], v13, s[40:43], s63 offen sc1
  v_xor_b32 v24, v14, v15
  v_subrev_u32 v25, s11, v14
  v_cmp_eq_u32 s[12:13], s9, v24
  v_cmp_gt_u32 vcc, 0x100000, v25
  s_and_b64 s[12:13], s[12:13], vcc
  s_waitcnt vmcnt(0)
  v_cmp_ne_u64 vcc, v[14:15], v[22:23]
  s_mov_b32 s33, s7
  s_or_b64 s[12:13], s[12:13], vcc
L_w_first:
  s_add_u32 s17, s0, s16
  s_and_b32 s17, s17, 15
  s_lshl_b32 s5, s17, 2
L_chk0:
  s_lshr_b64 s[6:7], s[12:13], s5
  s_and_b32 s6, s6, 15
  s_cmp_eq_u32 s6, 15
  s_cbranch_scc1 L_rdy0
  buffer_load_dwordx2 v[22:23], v13, s[40:43], s63 offen sc1
  s_waitcnt vmcnt(0)
  v_cmp_ne_u64 vcc, v[14:15], v[22:23]
  s_sub_u32 s62, s62, 1
  s_or_b64 s[12:13], s[12:13], vcc
  s_and_b32 s6, s62, 3
  s_cbranch_scc1 L_chk0
  s_call_b64 s[60:61], L_fallback
  s_branch L_chk0
L_rdy0:
  s_lshl_b32 s6, s19, 4
  s_add_u32 s17, s17, s6
  s_mul_i32 s17, s17, 14336
  s_add_u32 m0, s22, 32768
  s_nop 0
  buffer_load_dwordx4 v5, s[40:43], s17 offen offset:0 sc1 lds
  buffer_load_dwordx4 v5, s[40:43], s17 offen offset:1024 sc1 lds
  buffer_load_dwordx4 v5, s[40:43], s17 offen offset:2048 sc1 lds
  buffer_load_dwordx4 v5, s[40:43], s17 offen offset:3072 sc1 lds
  s_add_u32 m0, m0, 4096
  s_nop 0
  buffer_load_dwordx4 v16, s[40:43], s17 offen offset:0 sc1 lds
  buffer_load_dwordx4 v16, s[40:43], s17 offen offset:1024 sc1 lds
  buffer_load_dwordx4 v16, s[40:43], s17 offen offset:2048 sc1 lds
  buffer_load_dwordx4 v16, s[40:43], s17 offen offset:3072 sc1 lds
  s_add_u32 m0, m0, 4096
  s_nop 0
  buffer_load_dwordx4 v17, s[40:43], s17 offen offset:0 sc1 lds
  buffer_load_dwordx4 v17, s[40:43], s17 offen offset:1024 sc1 lds
  buffer_load_dwordx4 v17, s[40:43], s17 offen offset:2048 sc1 lds
  buffer_load_dwordx4 v17, s[40:43], s17 offen offset:3072 sc1 lds
  s_add_u32 m0, m0, 4096
  s_nop 0
  buffer_load_dwordx4 v18, s[40:43], s17 offen offset:0 sc1 lds
  buffer_load_dwordx4 v18, s[40:43], s17 offen offset:1024 sc1 lds
  s_lshr_b64 s[0:1], s[0:1], 4
  s_add_u32 s23, s23, 1
  s_add_u32 s22, s22, 47104
  s_cmp_eq_u32 s22, 141312
  s_cselect_b32 s22, 0, s22
  s_cmp_lt_u32 s23, 4
  s_cbranch_scc1 L_w_first
  s_waitcnt vmcnt(14)
  s_barrier
  s_add_u32 s17, s0, s16
  s_and_b32 s17, s17, 15
  s_lshl_b32 s5, s17, 2
L_chk1:
  s_lshr_b64 s[6:7], s[12:13], s5
  s_and_b32 s6, s6, 15
  s_cmp_eq_u32 s6, 15
  s_cbranch_scc1 L_rdy1
  buffer_load_dwordx2 v[22:23], v13, s[40:43], s63 offen sc1
  s_waitcnt vmcnt(0)
  v_cmp_ne_u64 vcc, v[14:15], v[22:23]
  s_sub_u32 s62, s62, 1
  s_or_b64 s[12:13], s[12:13], vcc
  s_and_b32 s6, s62, 3
  s_cbranch_scc1 L_chk1
  s_call_b64 s[60:61], L_fallback
  s_branch L_chk1
L_rdy1:
  s_lshl_b32 s6, s19, 4
  s_add_u32 s17, s17, s6
  s_mul_i32 s17, s17, 14336
  s_add_u32 m0, s22, 32768
  s_nop 0
  buffer_load_dwordx4 v5, s[40:43], s17 offen offset:0 sc1 lds
  buffer_load_dwordx4 v5, s[40:43], s17 offen offset:1024 sc1 lds
  buffer_load_dwordx4 v5, s[40:43], s17 offen offset:2048 sc1 lds
  buffer_load_dwordx4 v5, s[40:43], s17 offen offset:3072 sc1 lds
  s_add_u32 m0, m0, 4096
  s_nop 0
  buffer_load_dwordx4 v16, s[40:43], s17 offen offset:0 sc1 lds
  buffer_load_dwordx4 v16, s[40:43], s17 offen offset:1024 sc1 lds
  buffer_load_dwordx4 v16, s[40:43], s17 offen offset:2048 sc1 lds
  buffer_load_dwordx4 v16, s[40:43], s17 offen offset:3072 sc1 lds
  s_add_u32 m0, m0, 4096
  s_nop 0
  buffer_load_dwordx4 v17, s[40:43], s17 offen offset:0 sc1 lds
  buffer_load_dwordx4 v17, s[40:43], s17 offen offset:1024 sc1 lds
  buffer_load_dwordx4 v17, s[40:43], s17 offen offset:2048 sc1 lds
  buffer_load_dwordx4 v17, s[40:43], s17 offen offset:3072 sc1 lds
  s_add_u32 m0, m0, 4096
  s_nop 0
  buffer_load_dwordx4 v18, s[40:43], s17 offen offset:0 sc1 lds
  buffer_load_dwordx4 v18, s[40:43], s17 offen offset:1024 sc1 lds
  s_lshr_b64 s[0:1], s[0:1], 4
  s_add_u32 s23, s23, 1
  s_add_u32 s22, s22, 47104
  s_cmp_eq_u32 s22, 141312
  s_cselect_b32 s22, 0, s22
  s_mov_b32 s7, s33
  buffer_store_dwordx4 v[168:171], v5, s[40:43], s7 offen offset:0 sc1
  buffer_store_dwordx4 v[172:175], v5, s[40:43], s7 offen offset:1024 sc1
  buffer_store_dwordx4 v[176:179], v5, s[40:43], s7 offen offset:2048 sc1
  s_waitcnt vmcnt(17)
  s_barrier
  s_add_u32 s17, s0, s16
  s_and_b32 s17, s17, 15
  s_lshl_b32 s5, s17, 2
L_chk2:
  s_lshr_b64 s[6:7], s[12:13], s5
  s_and_b32 s6, s6, 15
  s_cmp_eq_u32 s6, 15
  s_cbranch_scc1 L_rdy2
  buffer_load_dwordx2 v[22:23], v13, s[40:43], s63 offen sc1
  s_waitcnt vmcnt(0)
  v_cmp_ne_u64 vcc, v[14:15], v[22:23]
  s_sub_u32 s62, s62, 1
  s_or_b64 s[12:13], s[12:13], vcc
  s_and_b32 s6, s62, 3
  s_cbranch_scc1 L_chk2
  s_call_b64 s[60:61], L_fallback
  s_branch L_chk2
L_rdy2:
  s_lshl_b32 s6, s19, 4
  s_add_u32 s17, s17, s6
  s_mul_i32 s17, s17, 14336
  s_add_u32 m0, s22, 32768
  s_nop 0
  buffer_load_dwordx4 v5, s[40:43], s17 offen offset:0 sc1 lds
  buffer_load_dwordx4 v5, s[40:43], s17 offen offset:1024 sc1 lds
  buffer_load_dwordx4 v5, s[40:43], s17 offen offset:2048 sc1 lds
  buffer_load_dwordx4 v5, s[40:43], s17 offen offset:3072 sc1 lds
  s_add_u32 m0, m0, 4096
  s_nop 0
  buffer_load_dwordx4 v16, s[40:43], s17 offen offset:0 sc1 lds
  buffer_load_dwordx4 v16, s[40:43], s17 offen offset:1024 sc1 lds
  buffer_load_dwordx4 v16, s[40:43], s17 offen offset:2048 sc1 lds
  buffer_load_dwordx4 v16, s[40:43], s17 offen offset:3072 sc1 lds
  s_add_u32 m0, m0, 4096
  s_nop 0
  buffer_load_dwordx4 v17, s[40:43], s17 offen offset:0 sc1 lds
  buffer_load_dwordx4 v17, s[40:43], s17 offen offset:1024 sc1 lds
  buffer_load_dwordx4 v17, s[40:43], s17 offen offset:2048 sc1 lds
  buffer_load_dwordx4 v17, s[40:43], s17 offen offset:3072 sc1 lds
  s_add_u32 m0, m0, 4096
  s_nop 0
  buffer_load_dwordx4 v18, s[40:43], s17 offen offset:0 sc1 lds
  buffer_load_dwordx4 v18, s[40:43], s17 offen offset:1024 sc1 lds
  s_lshr_b64 s[0:1], s[0:1], 4
  s_add_u32 s23, s23, 1
  s_add_u32 s22, s22, 47104
  s_cmp_eq_u32 s22, 141312
  s_cselect_b32 s22, 0, s22
  s_waitcnt vmcnt(14)
  s_barrier
  s_add_u32 s17, s0, s16
  s_and_b32 s17, s17, 15
  s_lshl_b32 s5, s17, 2
L_chk3:
  s_lshr_b64 s[6:7], s[12:13], s5
  s_and_b32 s6, s6, 15
  s_cmp_eq_u32 s6, 15
  s_cbranch_scc1 L_rdy3
  buffer_load_dwordx2 v[22:23], v13, s[40:43], s63 offen sc1
  s_waitcnt vmcnt(0)
  v_cmp_ne_u64 vcc, v[14:15], v[22:23]
  s_sub_u32 s62, s62, 1
  s_or_b64 s[12:13], s[12:13], vcc
  s_and_b32 s6, s62, 3
  s_cbranch_scc1 L_chk3
  s_call_b64 s[60:61], L_fallback
  s_branch L_chk3
L_rdy3:
  s_lshl_b32 s6, s19, 4
  s_add_u32 s17, s17, s6
  s_mul_i32 s17, s17, 14336
  s_add_u32 m0, s22, 32768
  s_nop 0
  buffer_load_dwordx4 v5, s[40:43], s17 offen offset:0 sc1 lds
  buffer_load_dwordx4 v5, s[40:43], s17 offen offset:1024 sc1 lds
  buffer_load_dwordx4 v5, s[40:43], s17 offen offset:2048 sc1 lds
  buffer_load_dwordx4 v5, s[40:43], s17 offen offset:3072 sc1 lds
  s_add_u32 m0, m0, 4096
  s_nop 0
  buffer_load_dwordx4 v16, s[40:43], s17 offen offset:0 sc1 lds
  buffer_load_dwordx4 v16, s[40:43], s17 offen offset:1024 sc1 lds
  buffer_load_dwordx4 v16, s[40:43], s17 offen offset:2048 sc1 lds
  buffer_load_dwordx4 v16, s[40:43], s17 offen offset:3072 sc1 lds
  s_add_u32 m0, m0, 4096
  s_nop 0
  buffer_load_dwordx4 v17, s[40:43], s17 offen offset:0 sc1 lds
  buffer_load_dwordx4 v17, s[40:43], s17 offen offset:1024 sc1 lds
  buffer_load_dwordx4 v17, s[40:43], s17 offen offset:2048 sc1 lds
  buffer_load_dwordx4 v17, s[40:43], s17 offen offset:3072 sc1 lds
  s_add_u32 m0, m0, 4096
  s_nop 0
  buffer_load_dwordx4 v18, s[40:43], s17 offen offset:0 sc1 lds
  buffer_load_dwordx4 v18, s[40:43], s17 offen offset:1024 sc1 lds
  s_lshr_b64 s[0:1], s[0:1], 4
  s_add_u32 s23, s23, 1
  s_add_u32 s22, s22, 47104
  s_cmp_eq_u32 s22, 141312
  s_cselect_b32 s22, 0, s22
  s_mov_b64 exec, 1
  buffer_store_dwordx2 v[184:185], v186, s[40:43], 0 offen sc1
  s_mov_b64 exec, -1
  s_waitcnt vmcnt(15)
  s_barrier
  s_add_u32 s17, s0, s16
  s_and_b32 s17, s17, 15
  s_lshl_b32 s5, s17, 2
L_chk4:
  s_lshr_b64 s[6:7], s[12:13], s5
  s_and_b32 s6, s6, 15
  s_cmp_eq_u32 s6, 15
  s_cbranch_scc1 L_rdy4
  buffer_load_dwordx2 v[22:23], v13, s[40:43], s63 offen sc1
  s_waitcnt vmcnt(0)
  v_cmp_ne_u64 vcc, v[14:15], v[22:23]
  s_sub_u32 s62, s62, 1
  s_or_b64 s[12:13], s[12:13], vcc
  s_and_b32 s6, s62, 3
  s_cbranch_scc1 L_chk4
  s_call_b64 s[60:61], L_fallback
  s_branch L_chk4
L_rdy4:
  s_lshl_b32 s6, s19, 4
  s_add_u32 s17, s17, s6
  s_mul_i32 s17, s17, 14336
  s_add_u32 m0, s22, 32768
  s_nop 0
  buffer_load_dwordx4 v5, s[40:43], s17 offen offset:0 sc1 lds
  buffer_load_dwordx4 v5, s[40:43], s17 offen offset:1024 sc1 lds
  buffer_load_dwordx4 v5, s[40:43], s17 offen offset:2048 sc1 lds
  buffer_load_dwordx4 v5, s[40:43], s17 offen offset:3072 sc1 lds
  s_add_u32 m0, m0, 4096
  s_nop 0
  buffer_load_dwordx4 v16, s[40:43], s17 offen offset:0 sc1 lds
  buffer_load_dwordx4 v16, s[40:43], s17 offen offset:1024 sc1 lds
  buffer_load_dwordx4 v16, s[40:43], s17 offen offset:2048 sc1 lds
  buffer_load_dwordx4 v16, s[40:43], s17 offen offset:3072 sc1 lds
  s_add_u32 m0, m0, 4096
  s_nop 0
  buffer_load_dwordx4 v17, s[40:43], s17 offen offset:0 sc1 lds
  buffer_load_dwordx4 v17, s[40:43], s17 offen offset:1024 sc1 lds
  buffer_load_dwordx4 v17, s[40:43], s17 offen offset:2048 sc1 lds
  buffer_load_dwordx4 v17, s[40:43], s17 offen offset:3072 sc1 lds
  s_add_u32 m0, m0, 4096
  s_nop 0
  buffer_load_dwordx4 v18, s[40:43], s17 offen offset:0 sc1 lds
  buffer_load_dwordx4 v18, s[40:43], s17 offen offset:1024 sc1 lds
  s_lshr_b64 s[0:1], s[0:1], 4
  s_add_u32 s23, s23, 1
  s_add_u32 s22, s22, 47104
  s_cmp_eq_u32 s22, 141312
  s_cselect_b32 s22, 0, s22
  s_waitcnt vmcnt(15)
  s_barrier
L_w_loop:
  s_add_u32 s17, s0, s16
  s_and_b32 s17, s17, 15
  s_lshl_b32 s5, s17, 2
L_chk5:
  s_lshr_b64 s[6:7], s[12:13], s5
  s_and_b32 s6, s6, 15
  s_cmp_eq_u32 s6, 15
  s_cbranch_scc1 L_rdy5
  buffer_load_dwordx2 v[22:23], v13, s[40:43], s63 offen sc1
  s_waitcnt vmcnt(0)
  v_cmp_ne_u64 vcc, v[14:15], v[22:23]
  s_sub_u32 s62, s62, 1
  s_or_b64 s[12:13], s[12:13], vcc
  s_and_b32 s6, s62, 3
  s_cbranch_scc1 L_chk5
  s_call_b64 s[60:61], L_fallback
  s_branch L_chk5
L_rdy5:
  s_lshl_b32 s6, s19, 4
  s_add_u32 s17, s17, s6
  s_mul_i32 s17, s17, 14336
  s_add_u32 m0, s22, 32768
  s_nop 0
  buffer_load_dwordx4 v5, s[40:43], s17 offen offset:0 sc1 lds
  buffer_load_dwordx4 v5, s[40:43], s17 offen offset:1024 sc1 lds
  buffer_load_dwordx4 v5, s[40:43], s17 offen offset:2048 sc1 lds
  buffer_load_dwordx4 v5, s[40:43], s17 offen offset:3072 sc1 lds
  s_add_u32 m0, m0, 4096
  s_nop 0
  buffer_load_dwordx4 v16, s[40:43], s17 offen offset:0 sc1 lds
  buffer_load_dwordx4 v16, s[40:43], s17 offen offset:1024 sc1 lds
  buffer_load_dwordx4 v16, s[40:43], s17 offen offset:2048 sc1 lds
  buffer_load_dwordx4 v16, s[40:43], s17 offen offset:3072 sc1 lds
  s_add_u32 m0, m0, 4096
  s_nop 0
  buffer_load_dwordx4 v17, s[40:43], s17 offen offset:0 sc1 lds
  buffer_load_dwordx4 v17, s[40:43], s17 offen offset:1024 sc1 lds
  buffer_load_dwordx4 v17, s[40:43], s17 offen offset:2048 sc1 lds
  buffer_load_dwordx4 v17, s[40:43], s17 offen offset:3072 sc1 lds
  s_add_u32 m0, m0, 4096
  s_nop 0
  buffer_load_dwordx4 v18, s[40:43], s17 offen offset:0 sc1 lds
  buffer_load_dwordx4 v18, s[40:43], s17 offen offset:1024 sc1 lds
  s_lshr_b64 s[0:1], s[0:1], 4
  s_add_u32 s23, s23, 1
  s_add_u32 s22, s22, 47104
  s_cmp_eq_u32 s22, 141312
  s_cselect_b32 s22, 0, s22
  s_waitcnt vmcnt(14)
  s_barrier
  s_cmp_lt_u32 s23, 16
  s_cbranch_scc1 L_w_loop
L_htail:
  v_mul_u32_u24 v1, 10923, v2
  v_lshrrev_b32 v1, 16, v1
  v_mul_u32_u24 v30, 6, v1
  v_sub_u32 v30, v2, v30
  v_lshlrev_b32 v30, 4, v30
  v_mul_u32_u24 v31, 112, v1
  v_add_u32 v31, v31, v30
  s_lshr_b32 s5, s21, 1
  s_mul_i32 s5, s5, 47104
  s_and_b32 s6, s21, 1
  s_mul_i32 s6, s6, 7168
  s_add_u32 s5, s5, s6
  s_add_u32 s5, s5, 36864
  v_add_u32 v32, s5, v31
  s_mul_i32 s5, s21, 5376
  s_add_u32 s5, s5, 141312
  v_add_u32 v31, s5, v31
  s_lshl_b32 s5, s100, 1
  s_lshl_b32 s6, s101, 1
  s_sub_u32 s6, s6, 64
  v_cmp_gt_u32 vcc, 64, v30
  v_mov_b32 v33, s6
  v_mov_b32 v34, s5
  v_mul_u32_u24 v1, 7168, v1
  v_cndmask_b32 v33, v33, v34, vcc
  v_add3_u32 v30, v30, v1, v33
  s_mul_i32 s5, s21, 9216
  s_add_u32 s5, s5, 47104
  v_lshrrev_b32 v1, 3, v2
  v_and_b32 v34, 7, v2
  v_lshlrev_b32 v34, 4, v34
  v_mul_u32_u24 v33, 144, v1
  v_add3_u32 v33, v33, v34, s5
  v_mul_u32_u24 v1, 7168, v1
  s_lshl_b32 s6, s99, 1
  v_add3_u32 v34, v34, v1, s6
  s_lshl_b32 s9, s18, 8
  s_lshl_b32 s6, s21, 6
  s_add_u32 s9, s9, s6
  s_mul_i32 s9, s9, 7168
  s_mul_i32 s6, s19, 224
  s_add_u32 s9, s9, s6
  s_mov_b32 s8, s9
  s_waitcnt vmcnt(0)
  s_barrier
  s_barrier
  s_barrier
  s_mov_b32 exec_hi, 0xffff
  ds_read_b128 v[40:43], v31 offset:0
  ds_read_b128 v[44:47], v31 offset:896
  ds_read_b128 v[48:51], v31 offset:1792
  ds_read_b128 v[52:55], v31 offset:2688
  ds_read_b128 v[56:59], v31 offset:3584
  ds_read_b128 v[60:63], v31 offset:4480
  ds_read_b128 v[64:67], v32 offset:0
  ds_read_b128 v[68:71], v32 offset:896
  s_waitcnt lgkmcnt(7)
  buffer_store_dwordx4 v[40:43], v30, s[44:47], s9 offen nt
  s_add_u32 s9, s9, 57344
  s_waitcnt lgkmcnt(6)
  buffer_store_dwordx4 v[44:47], v30, s[44:47], s9 offen nt
  s_add_u32 s9, s9, 57344
  s_waitcnt lgkmcnt(5)
  buffer_store_dwordx4 v[48:51], v30, s[44:47], s9 offen nt
  s_add_u32 s9, s9, 57344
  s_waitcnt lgkmcnt(4)
  buffer_store_dwordx4 v[52:55], v30, s[44:47], s9 offen nt
  s_add_u32 s9, s9, 57344
  s_waitcnt lgkmcnt(3)
  buffer_store_dwordx4 v[56:59], v30, s[44:47], s9 offen nt
  s_add_u32 s9, s9, 57344
  s_waitcnt lgkmcnt(2)
  buffer_store_dwordx4 v[60:63], v30, s[44:47], s9 offen nt
  s_add_u32 s9, s9, 57344
  s_waitcnt lgkmcnt(1)
  buffer_store_dwordx4 v[64:67], v30, s[44:47], s9 offen nt
  s_add_u32 s9, s9, 57344
  s_waitcnt lgkmcnt(0)
  buffer_store_dwordx4 v[68:71], v30, s[44:47], s9 offen nt
  s_mov_b32 exec_hi, -1
  s_barrier
  ds_read_b128 v[72:75], v33 offset:0
  ds_read_b128 v[76:79], v33 offset:1152
  ds_read_b128 v[80:83], v33 offset:2304
  ds_read_b128 v[84:87], v33 offset:3456
  s_waitcnt lgkmcnt(3)
  buffer_store_dwordx4 v[72:75], v34, s[44:47], s8 offen sc1
  s_add_u32 s8, s8, 57344
  s_waitcnt lgkmcnt(2)
  buffer_store_dwordx4 v[76:79], v34, s[44:47], s8 offen sc1
  s_add_u32 s8, s8, 57344
  s_waitcnt lgkmcnt(1)
  buffer_store_dwordx4 v[80:83], v34, s[44:47], s8 offen sc1
  s_add_u32 s8, s8, 57344
  s_waitcnt lgkmcnt(0)
  buffer_store_dwordx4 v[84:87], v34, s[44:47], s8 offen sc1
L_done:
  s_endpgm
L_fallback:
  s_lshr_b64 s[6:7], s[12:13], s5
  s_and_b32 s6, s6, 15
  s_cmp_eq_u32 s6, 15
  s_cbranch_scc1 L_fb_ret
  s_lshr_b32 s4, s17, 1
  s_cmp_gt_i32 s62, 0
  s_cbranch_scc1 L_fb_ret
  s_mov_b32 s62, 1
  s_mov_b32 s8, 0
  s_mov_b32 s9, 0
  s_mov_b32 s14, 0
L_fb_loop:
  s_add_u32 s7, s99, s14
  s_mov_b32 s6, 2
  s_add_u32 s3, s100, s14
  s_sub_u32 s3, s3, 4
  s_cmp_ge_u32 s14, 4
  s_cselect_b32 s7, s3, s7
  s_cselect_b32 s6, 1, s6
  s_cmp_eq_u32 s14, 6
  s_cselect_b32 s7, s101, s7
  s_cselect_b32 s6, 0, s6
  v_lshlrev_b32 v24, s6, v3
  v_add_u32 v24, s7, v24
  v_lshlrev_b32 v25, 1, v24
  v_lshl_add_u32 v24, v24, 2, v7
  s_mul_i32 s6, s4, 7168
  s_mul_i32 s7, s19, 224
  s_add_u32 s6, s6, s7
  buffer_load_ushort v26, v25, s[36:39], s6 offen
  s_lshl_b32 s6, s17, 1
  s_add_u32 s6, s6, s9
  s_mul_i32 s6, s6, 458752
  s_mul_i32 s7, s19, 448
  s_add_u32 s6, s6, s7
  buffer_load_dword v32, v24, s[28:31], s6 offen
  s_add_u32 s6, s6, 14336
  buffer_load_dword v33, v24, s[28:31], s6 offen
  s_add_u32 s6, s6, 14336
  buffer_load_dword v34, v24, s[28:31], s6 offen
  s_add_u32 s6, s6, 14336
  buffer_load_dword v35, v24, s[28:31], s6 offen
  s_add_u32 s6, s6, 14336
  buffer_load_dword v36, v24, s[28:31], s6 offen
  s_add_u32 s6, s6, 14336
  buffer_load_dword v37, v24, s[28:31], s6 offen
  s_add_u32 s6, s6, 14336
  buffer_load_dword v38, v24, s[28:31], s6 offen
  s_add_u32 s6, s6, 14336
  buffer_load_dword v39, v24, s[28:31], s6 offen
  s_waitcnt vmcnt(0)
  v_lshlrev_b32 v26, 16, v26
  v_lshlrev_b32 v32, 2, v32
  v_lshlrev_b32 v33, 2, v33
  v_lshlrev_b32 v34, 2, v34
  v_lshlrev_b32 v35, 2, v35
  v_lshlrev_b32 v36, 2, v36
  v_lshlrev_b32 v37, 2, v37
  v_lshlrev_b32 v38, 2, v38
  v_lshlrev_b32 v39, 2, v39
  ds_bpermute_b32 v32, v32, v12
  ds_bpermute_b32 v33, v33, v12
  ds_bpermute_b32 v34, v34, v12
  ds_bpermute_b32 v35, v35, v12
  ds_bpermute_b32 v36, v36, v12
  ds_bpermute_b32 v37, v37, v12
  ds_bpermute_b32 v38, v38, v12
  ds_bpermute_b32 v39, v39, v12
  s_waitcnt lgkmcnt(0)
  v_mul_f32 v32, v32, v26
  v_mul_f32 v33, v33, v26
  v_mul_f32 v34, v34, v26
  v_mul_f32 v35, v35, v26
  v_mul_f32 v36, v36, v26
  v_mul_f32 v37, v37, v26
  v_mul_f32 v38, v38, v26
  v_mul_f32 v39, v39, v26
  v_cvt_pk_bf16_f32 v28, v32, v33
  v_cvt_pk_bf16_f32 v29, v34, v35
  v_cvt_pk_bf16_f32 v30, v36, v37
  v_cvt_pk_bf16_f32 v31, v38, v39
  s_lshl_b32 s6, s19, 4
  s_add_u32 s6, s6, s17
  s_mul_i32 s6, s6, 14
  s_add_u32 s6, s6, s8
  s_lshl_b32 s6, s6, 10
  buffer_store_dwordx4 v[28:31], v5, s[40:43], s6 offen sc1
  s_add_u32 s14, s14, 1
  s_cmp_eq_u32 s14, 7
  s_cselect_b32 s14, 0, s14
  s_addc_u32 s9, s9, 0
  s_add_u32 s8, s8, 1
  s_cmp_lt_u32 s8, 14
  s_cbranch_scc1 L_fb_loop
  s_waitcnt vmcnt(0)
L_fb_set:
  s_lshl_b64 s[6:7], 15, s5
  s_or_b64 s[12:13], s[12:13], s[6:7]
L_fb_ret:
  s_setpc_b64 s[60:61]
L_end:
.section .rodata,"a"
.p2align 6
.amdhsa_kernel standalone__normalfloat_lut_codebook_lookup__prompt_kernel
  .amdhsa_next_free_vgpr 242
  .amdhsa_next_free_sgpr 102
  .amdhsa_accum_offset 244
  .amdhsa_group_segment_fixed_size 0
  .amdhsa_kernarg_size 56
  .amdhsa_user_sgpr_count 2
  .amdhsa_user_sgpr_kernarg_segment_ptr 1
  .amdhsa_system_sgpr_workgroup_id_x 1
  .amdhsa_float_denorm_mode_32 3
.end_amdhsa_kernel
```
